```python
import torch

def _softmax(x, axis=-1):
    return torch.softmax(x, dim=axis)
def _gelu(x):
    return torch.nn.functional.gelu(x, approximate="tanh")
def _silu(x):
    return torch.nn.functional.silu(x)
def _sigmoid(x):
    return torch.sigmoid(x)
def _layernorm(x, axis=-1, eps=1e-5):
    m = x.mean(dim=axis, keepdim=True)
    v = x.var(dim=axis, keepdim=True, unbiased=False)
    return (x - m) / torch.sqrt(v + eps)
def _scatter_add(tgt, idx, src, axis=0):
    return tgt.clone().index_add_(axis, idx, src)
def _segment_sum(src, seg, n):
    out = torch.zeros((n,) + src.shape[1:], dtype=src.dtype)
    return out.index_add_(0, seg, src)
def _pad(x, pw):
    flat = tuple(v for pair in reversed(pw) for v in pair)
    return torch.nn.functional.pad(x, flat)

kernel_name = 'concat_heads__sliding_block_cached__sliding_block_cached__decode'

def setup_inputs():

    _w = (lambda a: (lambda t: t.to(torch.bfloat16) if t.is_floating_point() else t)(torch.as_tensor(a)))
    def _A_setup():
        B, Sq, D = 4, 1, 640
        Hq, Hkv, Sk, Dh = 32, 32, 8192, 128
        assert Hq % Hkv == 0, (Hq, Hkv)
        return {
            "x": _w((lambda *s: torch.randn(*s, dtype=torch.bfloat16) * 0.8)(B, Sq, D)),
            "k_cache": _w((lambda *s: torch.randn(*s, dtype=torch.bfloat16) * 0.8)(B, Hkv, Sk, Dh)),
            "v_cache": _w((lambda *s: torch.randn(*s, dtype=torch.bfloat16) * 0.05)(B, Hkv, Sk, Dh)),
            "wq": _w((lambda *s: torch.randn(*s, dtype=torch.bfloat16) * 0.8)(D, Hq * Dh) * (D ** -0.5)),
            "wo": _w((lambda *s: torch.randn(*s, dtype=torch.bfloat16) * 0.05)(Hq * Dh, D) * ((Hq * Dh) ** -0.5)),
        }
    _A_in = _A_setup()

    def _B_setup():
        B, Sq, D = 4, 1, 640
        Hq, Hkv, Sk, Dh = 32, 32, 8192, 128
        assert Hq % Hkv == 0, (Hq, Hkv)
        return {
            "x": _w((lambda *s: torch.randn(*s, dtype=torch.bfloat16) * 0.8)(B, Sq, D)),
            "k_cache": _w((lambda *s: torch.randn(*s, dtype=torch.bfloat16) * 0.8)(B, Hkv, Sk, Dh)),
            "v_cache": _w((lambda *s: torch.randn(*s, dtype=torch.bfloat16) * 0.05)(B, Hkv, Sk, Dh)),
            "wq": _w((lambda *s: torch.randn(*s, dtype=torch.bfloat16) * 0.8)(D, Hq * Dh) * (D ** -0.5)),
            "wo": _w((lambda *s: torch.randn(*s, dtype=torch.bfloat16) * 0.05)(Hq * Dh, D) * ((Hq * Dh) ** -0.5)),
        }
    _B_in = _B_setup()

    return {
        "A_x": _A_in["x"],
        "A_k_cache": _A_in["k_cache"],
        "A_v_cache": _A_in["v_cache"],
        "A_wq": _A_in["wq"],
        "A_wo": _A_in["wo"],
        "B_x": _B_in["x"],
        "B_k_cache": _B_in["k_cache"],
        "B_v_cache": _B_in["v_cache"],
        "B_wq": _B_in["wq"],
        "B_wo": _B_in["wo"],
    }

def reference(A_x, A_k_cache, A_v_cache, A_wq, A_wo, B_x, B_k_cache, B_v_cache, B_wq, B_wo):
    def _A_ref(x, k_cache, v_cache, wq, wo):
        B, Sq, D = x.shape
        Hq, Dh = 32, 128
        Hkv, Sk = k_cache.shape[1], k_cache.shape[2]
        W = min(4096, max(256, Sk // 4))
        rep = Hq // Hkv
        q = (lambda x, *d: x.permute(*d))((x @ wq).reshape(B, Sq, Hq, Dh), 0, 2, 1, 3)
        k = (lambda x, n, axis: torch.repeat_interleave(x, n, dim=axis))(k_cache[:, :, Sk - W:, :], rep, axis=1)
        v = (lambda x, n, axis: torch.repeat_interleave(x, n, dim=axis))(v_cache[:, :, Sk - W:, :], rep, axis=1)
        scores = torch.einsum("bhqd,bhkd->bhqk", q, k) * (Dh ** -0.5)
        p = _softmax(scores, axis=-1)
        o = torch.einsum("bhqk,bhkd->bhqd", p, v)
        return (lambda x, *d: x.permute(*d))(o, 0, 2, 1, 3).reshape(B, Sq, Hq * Dh) @ wo

    def _B_ref(x, k_cache, v_cache, wq, wo):
        B, Sq, D = x.shape
        Hq, Dh = 32, 128
        Hkv, Sk = k_cache.shape[1], k_cache.shape[2]
        W = min(4096, max(256, Sk // 4))
        rep = Hq // Hkv
        q = (lambda x, *d: x.permute(*d))((x @ wq).reshape(B, Sq, Hq, Dh), 0, 2, 1, 3)
        k = (lambda x, n, axis: torch.repeat_interleave(x, n, dim=axis))(k_cache[:, :, Sk - W:, :], rep, axis=1)
        v = (lambda x, n, axis: torch.repeat_interleave(x, n, dim=axis))(v_cache[:, :, Sk - W:, :], rep, axis=1)
        scores = torch.einsum("bhqd,bhkd->bhqk", q, k) * (Dh ** -0.5)
        p = _softmax(scores, axis=-1)
        o = torch.einsum("bhqk,bhkd->bhqd", p, v)
        return (lambda x, *d: x.permute(*d))(o, 0, 2, 1, 3).reshape(B, Sq, Hq * Dh) @ wo

    a = _A_ref(A_x, A_k_cache, A_v_cache, A_wq, A_wo)
    b = _B_ref(B_x, B_k_cache, B_v_cache, B_wq, B_wo)
    return torch.concatenate([a, b], axis=-1)
```

```asm
; @launch grid=(256,1,1) block=(512,1,1) lds=28928
.amdgcn_target "amdgcn-amd-amdhsa--gfx950"
.text
.globl concat_heads__sliding_block_cached__sliding_block_cached__decode_kernel
.p2align 8
.type concat_heads__sliding_block_cached__sliding_block_cached__decode_kernel,@function
concat_heads__sliding_block_cached__sliding_block_cached__decode_kernel:
    s_cmp_ge_u32 s2, 256
    s_cbranch_scc1 L_end
    s_lshr_b32 s51, s2, 5
    s_and_b32 s51, s51, 1
    s_getreg_b32 s53, hwreg(HW_REG_XCC_ID)
    s_and_b32 s53, s53, 1
    s_cmp_eq_u32 s53, 1
    s_cbranch_scc1 L_bodyB
    s_mul_i32 s53, s51, 40
    s_load_dwordx8 s[4:11], s[0:1], s53
    s_load_dwordx2 s[12:13], s[0:1], s53 offset:32
    s_load_dwordx2 s[14:15], s[0:1], 80
    s_load_dwordx4 s[16:19], s[0:1], 88
    s_lshr_b32 s50, s2, 6
    s_and_b32 s52, s2, 31
    v_lshrrev_b32 v22, 6, v0
    v_and_b32 v23, 63, v0
    v_readfirstlane_b32 s48, v22
    v_lshlrev_b32 v1, 4, v23
    v_and_b32 v16, 15, v0
    v_bfe_u32 v17, v0, 4, 2
    v_lshlrev_b32 v11, 4, v16
    v_lshl_add_u32 v2, v17, 13, v11
    s_lshl_b32 s54, s52, 8
    s_mul_i32 s49, s50, 1280
    s_mov_b32 s38, 1280
    s_mov_b32 s39, 0x20000
    s_mov_b32 s31, 0x20000
    s_mov_b32 s30, 5234944
    s_mul_i32 s61, s50, 1
    s_mul_i32 s62, s48, 163840
    v_add_u32 v28, 0, v16
    v_mul_u32_u24 v29, 52, v28
    v_lshrrev_b32 v29, 8, v29
    v_mul_u32_u24 v30, 5, v29
    v_sub_u32 v30, v28, v30
    v_add_u32 v29, s61, v29
    v_and_b32 v29, 3, v29
    v_mul_u32_u24 v29, 160, v29
    v_lshl_add_u32 v29, v30, 2, v29
    v_add_u32 v29, v29, v17
    s_mul_i32 s55, s48, 20
    v_add_u32 v29, s55, v29
    v_lshlrev_b32 v24, 1, v29
    v_add_u32 v28, 16, v16
    v_mul_u32_u24 v29, 52, v28
    v_lshrrev_b32 v29, 8, v29
    v_mul_u32_u24 v30, 5, v29
    v_sub_u32 v30, v28, v30
    v_add_u32 v29, s61, v29
    v_and_b32 v29, 3, v29
    v_mul_u32_u24 v29, 160, v29
    v_lshl_add_u32 v29, v30, 2, v29
    v_add_u32 v29, v29, v17
    s_mul_i32 s55, s48, 20
    v_add_u32 v29, s55, v29
    v_lshlrev_b32 v25, 1, v29
    s_lshl_b32 s53, s50, 5
    s_add_u32 s53, s53, s52
    s_lshl_b32 s53, s53, 2
    s_add_u32 s53, s53, 3
    s_lshl_b32 s53, s53, 19
    s_mov_b32 s22, 0x80000
    s_mov_b32 s23, 0x20000
    s_lshl_b32 s63, s48, 12
    s_waitcnt lgkmcnt(0)
    s_add_u32 s28, s10, s54
    s_addc_u32 s29, s11, 0
    s_add_u32 s20, s6, s53
    s_addc_u32 s21, s7, 0
    s_add_u32 s36, s4, s49
    s_addc_u32 s37, s5, 0
    s_add_u32 s56, s61, 0
    s_and_b32 s56, s56, 3
    s_mul_i32 s56, s56, 1310720
    s_add_u32 s56, s56, s62
    buffer_load_dwordx4 v[76:79], v2, s[28:31], s56 offen
    s_add_u32 s56, s56, 32768
    buffer_load_dwordx4 v[80:83], v2, s[28:31], s56 offen
    s_add_u32 s56, s56, 32768
    buffer_load_dwordx4 v[84:87], v2, s[28:31], s56 offen
    s_add_u32 s56, s56, 32768
    buffer_load_dwordx4 v[88:91], v2, s[28:31], s56 offen
    s_add_u32 s56, s56, 32768
    buffer_load_dwordx4 v[92:95], v2, s[28:31], s56 offen
    buffer_load_ushort v8, v24, s[36:39], 0 offen
    buffer_load_ushort v9, v25, s[36:39], 0 offen
    s_cmp_ge_u32 s50, 2
    s_cbranch_scc1 L_stAA
    s_add_u32 s68, s63, 0
    buffer_load_dwordx4 v[156:159], v1, s[20:23], s68 offen offset:0 nt
    buffer_load_dwordx4 v[160:163], v1, s[20:23], s68 offen offset:1024 nt
    buffer_load_dwordx4 v[164:167], v1, s[20:23], s68 offen offset:2048 nt
    buffer_load_dwordx4 v[168:171], v1, s[20:23], s68 offen offset:3072 nt
    s_add_u32 s69, s63, 32768
    buffer_load_dwordx4 v[172:175], v1, s[20:23], s69 offen offset:0 nt
    buffer_load_dwordx4 v[176:179], v1, s[20:23], s69 offen offset:1024 nt
    buffer_load_dwordx4 v[180:183], v1, s[20:23], s69 offen offset:2048 nt
    buffer_load_dwordx4 v[184:187], v1, s[20:23], s69 offen offset:3072 nt
    s_barrier
    s_add_u32 s56, s61, 1
    s_and_b32 s56, s56, 3
    s_mul_i32 s56, s56, 1310720
    s_add_u32 s56, s56, s62
    buffer_load_dwordx4 v[96:99], v2, s[28:31], s56 offen
    s_add_u32 s56, s56, 32768
    buffer_load_dwordx4 v[100:103], v2, s[28:31], s56 offen
    s_add_u32 s56, s56, 32768
    buffer_load_dwordx4 v[104:107], v2, s[28:31], s56 offen
    s_add_u32 s56, s56, 32768
    buffer_load_dwordx4 v[108:111], v2, s[28:31], s56 offen
    s_add_u32 s56, s56, 32768
    buffer_load_dwordx4 v[112:115], v2, s[28:31], s56 offen
    s_add_u32 s56, s61, 2
    s_and_b32 s56, s56, 3
    s_mul_i32 s56, s56, 1310720
    s_add_u32 s56, s56, s62
    buffer_load_dwordx4 v[116:119], v2, s[28:31], s56 offen
    s_add_u32 s56, s56, 32768
    buffer_load_dwordx4 v[120:123], v2, s[28:31], s56 offen
    s_add_u32 s56, s56, 32768
    buffer_load_dwordx4 v[124:127], v2, s[28:31], s56 offen
    s_add_u32 s56, s56, 32768
    buffer_load_dwordx4 v[128:131], v2, s[28:31], s56 offen
    s_add_u32 s56, s56, 32768
    buffer_load_dwordx4 v[132:135], v2, s[28:31], s56 offen
    s_add_u32 s56, s61, 3
    s_and_b32 s56, s56, 3
    s_mul_i32 s56, s56, 1310720
    s_add_u32 s56, s56, s62
    buffer_load_dwordx4 v[136:139], v2, s[28:31], s56 offen
    s_add_u32 s56, s56, 32768
    buffer_load_dwordx4 v[140:143], v2, s[28:31], s56 offen
    s_add_u32 s56, s56, 32768
    buffer_load_dwordx4 v[144:147], v2, s[28:31], s56 offen
    s_add_u32 s56, s56, 32768
    buffer_load_dwordx4 v[148:151], v2, s[28:31], s56 offen
    s_add_u32 s56, s56, 32768
    buffer_load_dwordx4 v[152:155], v2, s[28:31], s56 offen
    s_mul_i32 s55, s52, 163840
    s_add_u32 s24, s8, s53
    s_addc_u32 s25, s9, 0
    s_mov_b32 s26, 0x80000
    s_mov_b32 s27, 0x20000
    s_add_u32 s32, s12, s55
    s_addc_u32 s33, s13, 0
    s_mov_b32 s34, 163840
    s_mov_b32 s35, 0x20000
    s_mul_i32 s57, s48, 20480
    v_mul_u32_u24 v3, 1280, v17
    v_add_u32 v3, v3, v11
    s_lshl_b32 s60, s51, 2
    s_add_u32 s60, s60, s50
    s_mul_i32 s54, s60, 163840
    s_add_u32 s40, s18, s54
    s_addc_u32 s41, s19, 0
    s_mov_b32 s42, 163840
    s_mov_b32 s43, 0x20000
    s_mul_i32 s54, s50, 2560
    s_mul_i32 s55, s51, 1280
    s_add_u32 s54, s54, s55
    s_add_u32 s44, s14, s54
    s_addc_u32 s45, s15, 0
    s_mov_b32 s46, 1280
    s_mov_b32 s47, 0x20000
    s_lshl_b32 s54, s60, 7
    s_add_u32 s54, s54, 1310720
    s_load_dwordx2 s[14:15], s[18:19], s54
    v_lshrrev_b32 v72, 3, v0
    v_lshlrev_b32 v72, 13, v72
    v_and_b32 v22, 7, v0
    v_lshl_add_u32 v72, v22, 4, v72
    s_lshl_b32 s54, s52, 8
    v_add_u32 v72, s54, v72
    s_barrier
    v_and_b32 v22, 1, v16
    v_lshlrev_b32 v22, 4, v22
    v_mov_b32 v23, 0xffff
    v_lshlrev_b32 v23, v22, v23
    v_lshrrev_b32 v22, 1, v16
    v_cmp_eq_u32 vcc, 0, v22
    s_nop 1
    v_cndmask_b32 v4, 0, v23, vcc
    v_cmp_eq_u32 vcc, 1, v22
    s_nop 1
    v_cndmask_b32 v5, 0, v23, vcc
    v_cmp_eq_u32 vcc, 2, v22
    s_nop 1
    v_cndmask_b32 v6, 0, v23, vcc
    v_cmp_eq_u32 vcc, 3, v22
    s_nop 1
    v_cndmask_b32 v7, 0, v23, vcc
    s_mov_b32 s58, 0x3e0293ee
    v_lshlrev_b32 v10, 7, v17
    v_lshl_add_u32 v10, v16, 2, v10
    s_lshl_b32 s54, s48, 9
    v_add_u32 v10, s54, v10
    v_lshlrev_b32 v73, 3, v17
    v_add_u32 v73, v73, v16
    v_lshlrev_b32 v73, 4, v73
    v_and_b32 v22, 3, v16
    v_lshl_add_u32 v22, v22, 2, v17
    s_lshl_b32 s54, s48, 4
    v_add_u32 v22, s54, v22
    v_lshrrev_b32 v23, 5, v22
    v_lshlrev_b32 v74, 3, v23
    v_and_b32 v23, 7, v22
    v_add_u32 v74, v74, v23
    v_lshlrev_b32 v74, 4, v74
    v_bfe_u32 v23, v22, 3, 2
    v_lshl_add_u32 v74, v23, 2, v74
    s_waitcnt vmcnt(23)
    v_lshl_or_b32 v8, v8, 16, v8
    v_lshl_or_b32 v9, v9, 16, v9
    s_nop 0
    v_and_b32_dpp v24, v8, v4 row_newbcast:0 row_mask:0xf bank_mask:0xf
    v_and_b32_dpp v25, v8, v5 row_newbcast:0 row_mask:0xf bank_mask:0xf
    v_and_b32_dpp v26, v8, v6 row_newbcast:0 row_mask:0xf bank_mask:0xf
    v_and_b32_dpp v27, v8, v7 row_newbcast:0 row_mask:0xf bank_mask:0xf
    s_nop 1
    v_mfma_f32_16x16x32_bf16 v[32:35], v[76:79], v[24:27], 0
    v_and_b32_dpp v28, v8, v4 row_newbcast:1 row_mask:0xf bank_mask:0xf
    v_and_b32_dpp v29, v8, v5 row_newbcast:1 row_mask:0xf bank_mask:0xf
    v_and_b32_dpp v30, v8, v6 row_newbcast:1 row_mask:0xf bank_mask:0xf
    v_and_b32_dpp v31, v8, v7 row_newbcast:1 row_mask:0xf bank_mask:0xf
    s_nop 1
    v_mfma_f32_16x16x32_bf16 v[32:35], v[80:83], v[28:31], v[32:35]
    v_and_b32_dpp v24, v8, v4 row_newbcast:2 row_mask:0xf bank_mask:0xf
    v_and_b32_dpp v25, v8, v5 row_newbcast:2 row_mask:0xf bank_mask:0xf
    v_and_b32_dpp v26, v8, v6 row_newbcast:2 row_mask:0xf bank_mask:0xf
    v_and_b32_dpp v27, v8, v7 row_newbcast:2 row_mask:0xf bank_mask:0xf
    s_nop 1
    v_mfma_f32_16x16x32_bf16 v[32:35], v[84:87], v[24:27], v[32:35]
    v_and_b32_dpp v28, v8, v4 row_newbcast:3 row_mask:0xf bank_mask:0xf
    v_and_b32_dpp v29, v8, v5 row_newbcast:3 row_mask:0xf bank_mask:0xf
    v_and_b32_dpp v30, v8, v6 row_newbcast:3 row_mask:0xf bank_mask:0xf
    v_and_b32_dpp v31, v8, v7 row_newbcast:3 row_mask:0xf bank_mask:0xf
    s_nop 1
    v_mfma_f32_16x16x32_bf16 v[32:35], v[88:91], v[28:31], v[32:35]
    v_and_b32_dpp v24, v8, v4 row_newbcast:4 row_mask:0xf bank_mask:0xf
    v_and_b32_dpp v25, v8, v5 row_newbcast:4 row_mask:0xf bank_mask:0xf
    v_and_b32_dpp v26, v8, v6 row_newbcast:4 row_mask:0xf bank_mask:0xf
    v_and_b32_dpp v27, v8, v7 row_newbcast:4 row_mask:0xf bank_mask:0xf
    s_nop 1
    v_mfma_f32_16x16x32_bf16 v[32:35], v[92:95], v[24:27], v[32:35]
    v_and_b32_dpp v28, v8, v4 row_newbcast:5 row_mask:0xf bank_mask:0xf
    v_and_b32_dpp v29, v8, v5 row_newbcast:5 row_mask:0xf bank_mask:0xf
    v_and_b32_dpp v30, v8, v6 row_newbcast:5 row_mask:0xf bank_mask:0xf
    v_and_b32_dpp v31, v8, v7 row_newbcast:5 row_mask:0xf bank_mask:0xf
    s_waitcnt vmcnt(14)
    s_nop 0
    v_mfma_f32_16x16x32_bf16 v[32:35], v[96:99], v[28:31], v[32:35]
    v_and_b32_dpp v24, v8, v4 row_newbcast:6 row_mask:0xf bank_mask:0xf
    v_and_b32_dpp v25, v8, v5 row_newbcast:6 row_mask:0xf bank_mask:0xf
    v_and_b32_dpp v26, v8, v6 row_newbcast:6 row_mask:0xf bank_mask:0xf
    v_and_b32_dpp v27, v8, v7 row_newbcast:6 row_mask:0xf bank_mask:0xf
    s_waitcnt vmcnt(13)
    s_nop 0
    v_mfma_f32_16x16x32_bf16 v[32:35], v[100:103], v[24:27], v[32:35]
    v_and_b32_dpp v28, v8, v4 row_newbcast:7 row_mask:0xf bank_mask:0xf
    v_and_b32_dpp v29, v8, v5 row_newbcast:7 row_mask:0xf bank_mask:0xf
    v_and_b32_dpp v30, v8, v6 row_newbcast:7 row_mask:0xf bank_mask:0xf
    v_and_b32_dpp v31, v8, v7 row_newbcast:7 row_mask:0xf bank_mask:0xf
    s_waitcnt vmcnt(12)
    s_nop 0
    v_mfma_f32_16x16x32_bf16 v[32:35], v[104:107], v[28:31], v[32:35]
    v_and_b32_dpp v24, v8, v4 row_newbcast:8 row_mask:0xf bank_mask:0xf
    v_and_b32_dpp v25, v8, v5 row_newbcast:8 row_mask:0xf bank_mask:0xf
    v_and_b32_dpp v26, v8, v6 row_newbcast:8 row_mask:0xf bank_mask:0xf
    v_and_b32_dpp v27, v8, v7 row_newbcast:8 row_mask:0xf bank_mask:0xf
    s_waitcnt vmcnt(11)
    s_nop 0
    v_mfma_f32_16x16x32_bf16 v[32:35], v[108:111], v[24:27], v[32:35]
    v_and_b32_dpp v28, v8, v4 row_newbcast:9 row_mask:0xf bank_mask:0xf
    v_and_b32_dpp v29, v8, v5 row_newbcast:9 row_mask:0xf bank_mask:0xf
    v_and_b32_dpp v30, v8, v6 row_newbcast:9 row_mask:0xf bank_mask:0xf
    v_and_b32_dpp v31, v8, v7 row_newbcast:9 row_mask:0xf bank_mask:0xf
    s_waitcnt vmcnt(10)
    s_nop 0
    v_mfma_f32_16x16x32_bf16 v[32:35], v[112:115], v[28:31], v[32:35]
    v_and_b32_dpp v24, v8, v4 row_newbcast:10 row_mask:0xf bank_mask:0xf
    v_and_b32_dpp v25, v8, v5 row_newbcast:10 row_mask:0xf bank_mask:0xf
    v_and_b32_dpp v26, v8, v6 row_newbcast:10 row_mask:0xf bank_mask:0xf
    v_and_b32_dpp v27, v8, v7 row_newbcast:10 row_mask:0xf bank_mask:0xf
    s_waitcnt vmcnt(9)
    s_nop 0
    v_mfma_f32_16x16x32_bf16 v[32:35], v[116:119], v[24:27], v[32:35]
    v_and_b32_dpp v28, v8, v4 row_newbcast:11 row_mask:0xf bank_mask:0xf
    v_and_b32_dpp v29, v8, v5 row_newbcast:11 row_mask:0xf bank_mask:0xf
    v_and_b32_dpp v30, v8, v6 row_newbcast:11 row_mask:0xf bank_mask:0xf
    v_and_b32_dpp v31, v8, v7 row_newbcast:11 row_mask:0xf bank_mask:0xf
    s_waitcnt vmcnt(8)
    s_nop 0
    v_mfma_f32_16x16x32_bf16 v[32:35], v[120:123], v[28:31], v[32:35]
    v_and_b32_dpp v24, v8, v4 row_newbcast:12 row_mask:0xf bank_mask:0xf
    v_and_b32_dpp v25, v8, v5 row_newbcast:12 row_mask:0xf bank_mask:0xf
    v_and_b32_dpp v26, v8, v6 row_newbcast:12 row_mask:0xf bank_mask:0xf
    v_and_b32_dpp v27, v8, v7 row_newbcast:12 row_mask:0xf bank_mask:0xf
    s_waitcnt vmcnt(7)
    s_nop 0
    v_mfma_f32_16x16x32_bf16 v[32:35], v[124:127], v[24:27], v[32:35]
    v_and_b32_dpp v28, v8, v4 row_newbcast:13 row_mask:0xf bank_mask:0xf
    v_and_b32_dpp v29, v8, v5 row_newbcast:13 row_mask:0xf bank_mask:0xf
    v_and_b32_dpp v30, v8, v6 row_newbcast:13 row_mask:0xf bank_mask:0xf
    v_and_b32_dpp v31, v8, v7 row_newbcast:13 row_mask:0xf bank_mask:0xf
    s_waitcnt vmcnt(6)
    s_nop 0
    v_mfma_f32_16x16x32_bf16 v[32:35], v[128:131], v[28:31], v[32:35]
    v_and_b32_dpp v24, v8, v4 row_newbcast:14 row_mask:0xf bank_mask:0xf
    v_and_b32_dpp v25, v8, v5 row_newbcast:14 row_mask:0xf bank_mask:0xf
    v_and_b32_dpp v26, v8, v6 row_newbcast:14 row_mask:0xf bank_mask:0xf
    v_and_b32_dpp v27, v8, v7 row_newbcast:14 row_mask:0xf bank_mask:0xf
    s_waitcnt vmcnt(5)
    s_nop 0
    v_mfma_f32_16x16x32_bf16 v[32:35], v[132:135], v[24:27], v[32:35]
    v_and_b32_dpp v28, v8, v4 row_newbcast:15 row_mask:0xf bank_mask:0xf
    v_and_b32_dpp v29, v8, v5 row_newbcast:15 row_mask:0xf bank_mask:0xf
    v_and_b32_dpp v30, v8, v6 row_newbcast:15 row_mask:0xf bank_mask:0xf
    v_and_b32_dpp v31, v8, v7 row_newbcast:15 row_mask:0xf bank_mask:0xf
    s_waitcnt vmcnt(4)
    s_nop 0
    v_mfma_f32_16x16x32_bf16 v[32:35], v[136:139], v[28:31], v[32:35]
    v_and_b32_dpp v24, v9, v4 row_newbcast:0 row_mask:0xf bank_mask:0xf
    v_and_b32_dpp v25, v9, v5 row_newbcast:0 row_mask:0xf bank_mask:0xf
    v_and_b32_dpp v26, v9, v6 row_newbcast:0 row_mask:0xf bank_mask:0xf
    v_and_b32_dpp v27, v9, v7 row_newbcast:0 row_mask:0xf bank_mask:0xf
    s_waitcnt vmcnt(3)
    s_nop 0
    v_mfma_f32_16x16x32_bf16 v[32:35], v[140:143], v[24:27], v[32:35]
    v_and_b32_dpp v28, v9, v4 row_newbcast:1 row_mask:0xf bank_mask:0xf
    v_and_b32_dpp v29, v9, v5 row_newbcast:1 row_mask:0xf bank_mask:0xf
    v_and_b32_dpp v30, v9, v6 row_newbcast:1 row_mask:0xf bank_mask:0xf
    v_and_b32_dpp v31, v9, v7 row_newbcast:1 row_mask:0xf bank_mask:0xf
    s_waitcnt vmcnt(2)
    s_nop 0
    v_mfma_f32_16x16x32_bf16 v[32:35], v[144:147], v[28:31], v[32:35]
    v_and_b32_dpp v24, v9, v4 row_newbcast:2 row_mask:0xf bank_mask:0xf
    v_and_b32_dpp v25, v9, v5 row_newbcast:2 row_mask:0xf bank_mask:0xf
    v_and_b32_dpp v26, v9, v6 row_newbcast:2 row_mask:0xf bank_mask:0xf
    v_and_b32_dpp v27, v9, v7 row_newbcast:2 row_mask:0xf bank_mask:0xf
    s_waitcnt vmcnt(1)
    s_nop 0
    v_mfma_f32_16x16x32_bf16 v[32:35], v[148:151], v[24:27], v[32:35]
    v_and_b32_dpp v28, v9, v4 row_newbcast:3 row_mask:0xf bank_mask:0xf
    v_and_b32_dpp v29, v9, v5 row_newbcast:3 row_mask:0xf bank_mask:0xf
    v_and_b32_dpp v30, v9, v6 row_newbcast:3 row_mask:0xf bank_mask:0xf
    v_and_b32_dpp v31, v9, v7 row_newbcast:3 row_mask:0xf bank_mask:0xf
    s_waitcnt vmcnt(0)
    s_nop 0
    v_mfma_f32_16x16x32_bf16 v[32:35], v[152:155], v[28:31], v[32:35]
    s_add_u32 s70, s63, 65536
    buffer_load_dwordx4 v[188:191], v1, s[20:23], s70 offen offset:0 nt
    buffer_load_dwordx4 v[192:195], v1, s[20:23], s70 offen offset:1024 nt
    buffer_load_dwordx4 v[196:199], v1, s[20:23], s70 offen offset:2048 nt
    buffer_load_dwordx4 v[200:203], v1, s[20:23], s70 offen offset:3072 nt
    s_branch L_stJA
L_stAA:
    s_add_u32 s68, s63, 0
    buffer_load_dwordx4 v[156:159], v1, s[20:23], s68 offen offset:0 nt
    buffer_load_dwordx4 v[160:163], v1, s[20:23], s68 offen offset:1024 nt
    s_barrier
    s_add_u32 s56, s61, 1
    s_and_b32 s56, s56, 3
    s_mul_i32 s56, s56, 1310720
    s_add_u32 s56, s56, s62
    buffer_load_dwordx4 v[96:99], v2, s[28:31], s56 offen
    s_add_u32 s56, s56, 32768
    buffer_load_dwordx4 v[100:103], v2, s[28:31], s56 offen
    s_add_u32 s56, s56, 32768
    buffer_load_dwordx4 v[104:107], v2, s[28:31], s56 offen
    s_add_u32 s56, s56, 32768
    buffer_load_dwordx4 v[108:111], v2, s[28:31], s56 offen
    s_add_u32 s56, s56, 32768
    buffer_load_dwordx4 v[112:115], v2, s[28:31], s56 offen
    s_add_u32 s56, s61, 2
    s_and_b32 s56, s56, 3
    s_mul_i32 s56, s56, 1310720
    s_add_u32 s56, s56, s62
    buffer_load_dwordx4 v[116:119], v2, s[28:31], s56 offen
    s_add_u32 s56, s56, 32768
    buffer_load_dwordx4 v[120:123], v2, s[28:31], s56 offen
    s_add_u32 s56, s56, 32768
    buffer_load_dwordx4 v[124:127], v2, s[28:31], s56 offen
    s_add_u32 s56, s56, 32768
    buffer_load_dwordx4 v[128:131], v2, s[28:31], s56 offen
    s_add_u32 s56, s56, 32768
    buffer_load_dwordx4 v[132:135], v2, s[28:31], s56 offen
    s_add_u32 s56, s61, 3
    s_and_b32 s56, s56, 3
    s_mul_i32 s56, s56, 1310720
    s_add_u32 s56, s56, s62
    buffer_load_dwordx4 v[136:139], v2, s[28:31], s56 offen
    s_add_u32 s56, s56, 32768
    buffer_load_dwordx4 v[140:143], v2, s[28:31], s56 offen
    s_add_u32 s56, s56, 32768
    buffer_load_dwordx4 v[144:147], v2, s[28:31], s56 offen
    s_add_u32 s56, s56, 32768
    buffer_load_dwordx4 v[148:151], v2, s[28:31], s56 offen
    s_add_u32 s56, s56, 32768
    buffer_load_dwordx4 v[152:155], v2, s[28:31], s56 offen
    s_mul_i32 s55, s52, 163840
    s_add_u32 s24, s8, s53
    s_addc_u32 s25, s9, 0
    s_mov_b32 s26, 0x80000
    s_mov_b32 s27, 0x20000
    s_add_u32 s32, s12, s55
    s_addc_u32 s33, s13, 0
    s_mov_b32 s34, 163840
    s_mov_b32 s35, 0x20000
    s_mul_i32 s57, s48, 20480
    v_mul_u32_u24 v3, 1280, v17
    v_add_u32 v3, v3, v11
    s_lshl_b32 s60, s51, 2
    s_add_u32 s60, s60, s50
    s_mul_i32 s54, s60, 163840
    s_add_u32 s40, s18, s54
    s_addc_u32 s41, s19, 0
    s_mov_b32 s42, 163840
    s_mov_b32 s43, 0x20000
    s_mul_i32 s54, s50, 2560
    s_mul_i32 s55, s51, 1280
    s_add_u32 s54, s54, s55
    s_add_u32 s44, s14, s54
    s_addc_u32 s45, s15, 0
    s_mov_b32 s46, 1280
    s_mov_b32 s47, 0x20000
    s_lshl_b32 s54, s60, 7
    s_add_u32 s54, s54, 1310720
    s_load_dwordx2 s[14:15], s[18:19], s54
    v_lshrrev_b32 v72, 3, v0
    v_lshlrev_b32 v72, 13, v72
    v_and_b32 v22, 7, v0
    v_lshl_add_u32 v72, v22, 4, v72
    s_lshl_b32 s54, s52, 8
    v_add_u32 v72, s54, v72
    s_barrier
    buffer_load_dwordx4 v[164:167], v1, s[20:23], s68 offen offset:2048 nt
    buffer_load_dwordx4 v[168:171], v1, s[20:23], s68 offen offset:3072 nt
    s_add_u32 s69, s63, 32768
    buffer_load_dwordx4 v[172:175], v1, s[20:23], s69 offen offset:0 nt
    buffer_load_dwordx4 v[176:179], v1, s[20:23], s69 offen offset:1024 nt
    v_and_b32 v22, 1, v16
    v_lshlrev_b32 v22, 4, v22
    v_mov_b32 v23, 0xffff
    v_lshlrev_b32 v23, v22, v23
    v_lshrrev_b32 v22, 1, v16
    v_cmp_eq_u32 vcc, 0, v22
    s_nop 1
    v_cndmask_b32 v4, 0, v23, vcc
    v_cmp_eq_u32 vcc, 1, v22
    s_nop 1
    v_cndmask_b32 v5, 0, v23, vcc
    v_cmp_eq_u32 vcc, 2, v22
    s_nop 1
    v_cndmask_b32 v6, 0, v23, vcc
    v_cmp_eq_u32 vcc, 3, v22
    s_nop 1
    v_cndmask_b32 v7, 0, v23, vcc
    s_mov_b32 s58, 0x3e0293ee
    v_lshlrev_b32 v10, 7, v17
    v_lshl_add_u32 v10, v16, 2, v10
    s_lshl_b32 s54, s48, 9
    v_add_u32 v10, s54, v10
    v_lshlrev_b32 v73, 3, v17
    v_add_u32 v73, v73, v16
    v_lshlrev_b32 v73, 4, v73
    v_and_b32 v22, 3, v16
    v_lshl_add_u32 v22, v22, 2, v17
    s_lshl_b32 s54, s48, 4
    v_add_u32 v22, s54, v22
    v_lshrrev_b32 v23, 5, v22
    v_lshlrev_b32 v74, 3, v23
    v_and_b32 v23, 7, v22
    v_add_u32 v74, v74, v23
    v_lshlrev_b32 v74, 4, v74
    v_bfe_u32 v23, v22, 3, 2
    v_lshl_add_u32 v74, v23, 2, v74
    s_waitcnt vmcnt(21)
    v_lshl_or_b32 v8, v8, 16, v8
    v_lshl_or_b32 v9, v9, 16, v9
    s_nop 0
    v_and_b32_dpp v24, v8, v4 row_newbcast:0 row_mask:0xf bank_mask:0xf
    v_and_b32_dpp v25, v8, v5 row_newbcast:0 row_mask:0xf bank_mask:0xf
    v_and_b32_dpp v26, v8, v6 row_newbcast:0 row_mask:0xf bank_mask:0xf
    v_and_b32_dpp v27, v8, v7 row_newbcast:0 row_mask:0xf bank_mask:0xf
    s_nop 1
    v_mfma_f32_16x16x32_bf16 v[32:35], v[76:79], v[24:27], 0
    v_and_b32_dpp v28, v8, v4 row_newbcast:1 row_mask:0xf bank_mask:0xf
    v_and_b32_dpp v29, v8, v5 row_newbcast:1 row_mask:0xf bank_mask:0xf
    v_and_b32_dpp v30, v8, v6 row_newbcast:1 row_mask:0xf bank_mask:0xf
    v_and_b32_dpp v31, v8, v7 row_newbcast:1 row_mask:0xf bank_mask:0xf
    s_nop 1
    v_mfma_f32_16x16x32_bf16 v[32:35], v[80:83], v[28:31], v[32:35]
    v_and_b32_dpp v24, v8, v4 row_newbcast:2 row_mask:0xf bank_mask:0xf
    v_and_b32_dpp v25, v8, v5 row_newbcast:2 row_mask:0xf bank_mask:0xf
    v_and_b32_dpp v26, v8, v6 row_newbcast:2 row_mask:0xf bank_mask:0xf
    v_and_b32_dpp v27, v8, v7 row_newbcast:2 row_mask:0xf bank_mask:0xf
    s_nop 1
    v_mfma_f32_16x16x32_bf16 v[32:35], v[84:87], v[24:27], v[32:35]
    v_and_b32_dpp v28, v8, v4 row_newbcast:3 row_mask:0xf bank_mask:0xf
    v_and_b32_dpp v29, v8, v5 row_newbcast:3 row_mask:0xf bank_mask:0xf
    v_and_b32_dpp v30, v8, v6 row_newbcast:3 row_mask:0xf bank_mask:0xf
    v_and_b32_dpp v31, v8, v7 row_newbcast:3 row_mask:0xf bank_mask:0xf
    s_nop 1
    v_mfma_f32_16x16x32_bf16 v[32:35], v[88:91], v[28:31], v[32:35]
    v_and_b32_dpp v24, v8, v4 row_newbcast:4 row_mask:0xf bank_mask:0xf
    v_and_b32_dpp v25, v8, v5 row_newbcast:4 row_mask:0xf bank_mask:0xf
    v_and_b32_dpp v26, v8, v6 row_newbcast:4 row_mask:0xf bank_mask:0xf
    v_and_b32_dpp v27, v8, v7 row_newbcast:4 row_mask:0xf bank_mask:0xf
    s_nop 1
    v_mfma_f32_16x16x32_bf16 v[32:35], v[92:95], v[24:27], v[32:35]
    v_and_b32_dpp v28, v8, v4 row_newbcast:5 row_mask:0xf bank_mask:0xf
    v_and_b32_dpp v29, v8, v5 row_newbcast:5 row_mask:0xf bank_mask:0xf
    v_and_b32_dpp v30, v8, v6 row_newbcast:5 row_mask:0xf bank_mask:0xf
    v_and_b32_dpp v31, v8, v7 row_newbcast:5 row_mask:0xf bank_mask:0xf
    s_waitcnt vmcnt(18)
    s_nop 0
    v_mfma_f32_16x16x32_bf16 v[32:35], v[96:99], v[28:31], v[32:35]
    v_and_b32_dpp v24, v8, v4 row_newbcast:6 row_mask:0xf bank_mask:0xf
    v_and_b32_dpp v25, v8, v5 row_newbcast:6 row_mask:0xf bank_mask:0xf
    v_and_b32_dpp v26, v8, v6 row_newbcast:6 row_mask:0xf bank_mask:0xf
    v_and_b32_dpp v27, v8, v7 row_newbcast:6 row_mask:0xf bank_mask:0xf
    s_waitcnt vmcnt(17)
    s_nop 0
    v_mfma_f32_16x16x32_bf16 v[32:35], v[100:103], v[24:27], v[32:35]
    v_and_b32_dpp v28, v8, v4 row_newbcast:7 row_mask:0xf bank_mask:0xf
    v_and_b32_dpp v29, v8, v5 row_newbcast:7 row_mask:0xf bank_mask:0xf
    v_and_b32_dpp v30, v8, v6 row_newbcast:7 row_mask:0xf bank_mask:0xf
    v_and_b32_dpp v31, v8, v7 row_newbcast:7 row_mask:0xf bank_mask:0xf
    s_waitcnt vmcnt(16)
    s_nop 0
    v_mfma_f32_16x16x32_bf16 v[32:35], v[104:107], v[28:31], v[32:35]
    v_and_b32_dpp v24, v8, v4 row_newbcast:8 row_mask:0xf bank_mask:0xf
    v_and_b32_dpp v25, v8, v5 row_newbcast:8 row_mask:0xf bank_mask:0xf
    v_and_b32_dpp v26, v8, v6 row_newbcast:8 row_mask:0xf bank_mask:0xf
    v_and_b32_dpp v27, v8, v7 row_newbcast:8 row_mask:0xf bank_mask:0xf
    s_waitcnt vmcnt(15)
    s_nop 0
    v_mfma_f32_16x16x32_bf16 v[32:35], v[108:111], v[24:27], v[32:35]
    v_and_b32_dpp v28, v8, v4 row_newbcast:9 row_mask:0xf bank_mask:0xf
    v_and_b32_dpp v29, v8, v5 row_newbcast:9 row_mask:0xf bank_mask:0xf
    v_and_b32_dpp v30, v8, v6 row_newbcast:9 row_mask:0xf bank_mask:0xf
    v_and_b32_dpp v31, v8, v7 row_newbcast:9 row_mask:0xf bank_mask:0xf
    s_waitcnt vmcnt(14)
    s_nop 0
    v_mfma_f32_16x16x32_bf16 v[32:35], v[112:115], v[28:31], v[32:35]
    v_and_b32_dpp v24, v8, v4 row_newbcast:10 row_mask:0xf bank_mask:0xf
    v_and_b32_dpp v25, v8, v5 row_newbcast:10 row_mask:0xf bank_mask:0xf
    v_and_b32_dpp v26, v8, v6 row_newbcast:10 row_mask:0xf bank_mask:0xf
    v_and_b32_dpp v27, v8, v7 row_newbcast:10 row_mask:0xf bank_mask:0xf
    s_waitcnt vmcnt(13)
    s_nop 0
    v_mfma_f32_16x16x32_bf16 v[32:35], v[116:119], v[24:27], v[32:35]
    v_and_b32_dpp v28, v8, v4 row_newbcast:11 row_mask:0xf bank_mask:0xf
    v_and_b32_dpp v29, v8, v5 row_newbcast:11 row_mask:0xf bank_mask:0xf
    v_and_b32_dpp v30, v8, v6 row_newbcast:11 row_mask:0xf bank_mask:0xf
    v_and_b32_dpp v31, v8, v7 row_newbcast:11 row_mask:0xf bank_mask:0xf
    s_waitcnt vmcnt(12)
    s_nop 0
    v_mfma_f32_16x16x32_bf16 v[32:35], v[120:123], v[28:31], v[32:35]
    v_and_b32_dpp v24, v8, v4 row_newbcast:12 row_mask:0xf bank_mask:0xf
    v_and_b32_dpp v25, v8, v5 row_newbcast:12 row_mask:0xf bank_mask:0xf
    v_and_b32_dpp v26, v8, v6 row_newbcast:12 row_mask:0xf bank_mask:0xf
    v_and_b32_dpp v27, v8, v7 row_newbcast:12 row_mask:0xf bank_mask:0xf
    s_waitcnt vmcnt(11)
    s_nop 0
    v_mfma_f32_16x16x32_bf16 v[32:35], v[124:127], v[24:27], v[32:35]
    v_and_b32_dpp v28, v8, v4 row_newbcast:13 row_mask:0xf bank_mask:0xf
    v_and_b32_dpp v29, v8, v5 row_newbcast:13 row_mask:0xf bank_mask:0xf
    v_and_b32_dpp v30, v8, v6 row_newbcast:13 row_mask:0xf bank_mask:0xf
    v_and_b32_dpp v31, v8, v7 row_newbcast:13 row_mask:0xf bank_mask:0xf
    s_waitcnt vmcnt(10)
    s_nop 0
    v_mfma_f32_16x16x32_bf16 v[32:35], v[128:131], v[28:31], v[32:35]
    v_and_b32_dpp v24, v8, v4 row_newbcast:14 row_mask:0xf bank_mask:0xf
    v_and_b32_dpp v25, v8, v5 row_newbcast:14 row_mask:0xf bank_mask:0xf
    v_and_b32_dpp v26, v8, v6 row_newbcast:14 row_mask:0xf bank_mask:0xf
    v_and_b32_dpp v27, v8, v7 row_newbcast:14 row_mask:0xf bank_mask:0xf
    s_waitcnt vmcnt(9)
    s_nop 0
    v_mfma_f32_16x16x32_bf16 v[32:35], v[132:135], v[24:27], v[32:35]
    v_and_b32_dpp v28, v8, v4 row_newbcast:15 row_mask:0xf bank_mask:0xf
    v_and_b32_dpp v29, v8, v5 row_newbcast:15 row_mask:0xf bank_mask:0xf
    v_and_b32_dpp v30, v8, v6 row_newbcast:15 row_mask:0xf bank_mask:0xf
    v_and_b32_dpp v31, v8, v7 row_newbcast:15 row_mask:0xf bank_mask:0xf
    s_waitcnt vmcnt(8)
    s_nop 0
    v_mfma_f32_16x16x32_bf16 v[32:35], v[136:139], v[28:31], v[32:35]
    v_and_b32_dpp v24, v9, v4 row_newbcast:0 row_mask:0xf bank_mask:0xf
    v_and_b32_dpp v25, v9, v5 row_newbcast:0 row_mask:0xf bank_mask:0xf
    v_and_b32_dpp v26, v9, v6 row_newbcast:0 row_mask:0xf bank_mask:0xf
    v_and_b32_dpp v27, v9, v7 row_newbcast:0 row_mask:0xf bank_mask:0xf
    s_waitcnt vmcnt(7)
    s_nop 0
    v_mfma_f32_16x16x32_bf16 v[32:35], v[140:143], v[24:27], v[32:35]
    v_and_b32_dpp v28, v9, v4 row_newbcast:1 row_mask:0xf bank_mask:0xf
    v_and_b32_dpp v29, v9, v5 row_newbcast:1 row_mask:0xf bank_mask:0xf
    v_and_b32_dpp v30, v9, v6 row_newbcast:1 row_mask:0xf bank_mask:0xf
    v_and_b32_dpp v31, v9, v7 row_newbcast:1 row_mask:0xf bank_mask:0xf
    s_waitcnt vmcnt(6)
    s_nop 0
    v_mfma_f32_16x16x32_bf16 v[32:35], v[144:147], v[28:31], v[32:35]
    v_and_b32_dpp v24, v9, v4 row_newbcast:2 row_mask:0xf bank_mask:0xf
    v_and_b32_dpp v25, v9, v5 row_newbcast:2 row_mask:0xf bank_mask:0xf
    v_and_b32_dpp v26, v9, v6 row_newbcast:2 row_mask:0xf bank_mask:0xf
    v_and_b32_dpp v27, v9, v7 row_newbcast:2 row_mask:0xf bank_mask:0xf
    s_waitcnt vmcnt(5)
    s_nop 0
    v_mfma_f32_16x16x32_bf16 v[32:35], v[148:151], v[24:27], v[32:35]
    v_and_b32_dpp v28, v9, v4 row_newbcast:3 row_mask:0xf bank_mask:0xf
    v_and_b32_dpp v29, v9, v5 row_newbcast:3 row_mask:0xf bank_mask:0xf
    v_and_b32_dpp v30, v9, v6 row_newbcast:3 row_mask:0xf bank_mask:0xf
    v_and_b32_dpp v31, v9, v7 row_newbcast:3 row_mask:0xf bank_mask:0xf
    s_waitcnt vmcnt(4)
    s_nop 0
    v_mfma_f32_16x16x32_bf16 v[32:35], v[152:155], v[28:31], v[32:35]
    buffer_load_dwordx4 v[180:183], v1, s[20:23], s69 offen offset:2048 nt
    buffer_load_dwordx4 v[184:187], v1, s[20:23], s69 offen offset:3072 nt
    s_add_u32 s70, s63, 65536
    buffer_load_dwordx4 v[188:191], v1, s[20:23], s70 offen offset:0 nt
    buffer_load_dwordx4 v[192:195], v1, s[20:23], s70 offen offset:1024 nt
    buffer_load_dwordx4 v[196:199], v1, s[20:23], s70 offen offset:2048 nt
    buffer_load_dwordx4 v[200:203], v1, s[20:23], s70 offen offset:3072 nt
L_stJA:
    s_nop 7
    s_mov_b32 exec_lo, 0x00ff00ff
    s_mov_b32 exec_hi, 0x00ff00ff
    ds_write_b32 v10, v32 offset:0
    ds_write_b32 v10, v33 offset:32
    ds_write_b32 v10, v34 offset:64
    ds_write_b32 v10, v35 offset:96
    s_mov_b64 exec, -1
    v_lshlrev_b32 v22, 3, v0
    v_and_b32 v22, 511, v22
    s_waitcnt lgkmcnt(0)
    s_barrier
    s_add_u32 s14, s14, 0x7f4a7c15
    s_addc_u32 s15, s15, 0x9e3779b9
    ds_read_b64 v[36:37], v22 offset:0
    ds_read_b64 v[38:39], v22 offset:512
    ds_read_b64 v[40:41], v22 offset:1024
    ds_read_b64 v[42:43], v22 offset:1536
    ds_read_b64 v[44:45], v22 offset:2048
    ds_read_b64 v[46:47], v22 offset:2560
    ds_read_b64 v[48:49], v22 offset:3072
    ds_read_b64 v[50:51], v22 offset:3584
    s_waitcnt lgkmcnt(0)
    v_add_f32 v36, v36, v38
    v_add_f32 v37, v37, v39
    v_add_f32 v36, v36, v40
    v_add_f32 v37, v37, v41
    v_add_f32 v36, v36, v42
    v_add_f32 v37, v37, v43
    v_add_f32 v36, v36, v44
    v_add_f32 v37, v37, v45
    v_add_f32 v36, v36, v46
    v_add_f32 v37, v37, v47
    v_add_f32 v36, v36, v48
    v_add_f32 v37, v37, v49
    v_add_f32 v36, v36, v50
    v_add_f32 v37, v37, v51
    v_cvt_pk_bf16_f32 v22, v36, v37
    ds_bpermute_b32 v12, v11, v22 offset:0
    ds_bpermute_b32 v13, v11, v22 offset:4
    ds_bpermute_b32 v14, v11, v22 offset:8
    ds_bpermute_b32 v15, v11, v22 offset:12
    s_waitcnt lgkmcnt(0)
    v_dot2_f32_bf16 v16, v156, v12, 0
    v_dot2_f32_bf16 v16, v157, v13, v16
    v_dot2_f32_bf16 v16, v158, v14, v16
    v_dot2_f32_bf16 v16, v159, v15, v16
    v_dot2_f32_bf16 v17, v160, v12, 0
    v_dot2_f32_bf16 v17, v161, v13, v17
    v_dot2_f32_bf16 v17, v162, v14, v17
    v_dot2_f32_bf16 v17, v163, v15, v17
    s_waitcnt vmcnt(9)
    v_dot2_f32_bf16 v18, v164, v12, 0
    v_dot2_f32_bf16 v18, v165, v13, v18
    v_dot2_f32_bf16 v18, v166, v14, v18
    v_dot2_f32_bf16 v18, v167, v15, v18
    s_waitcnt vmcnt(8)
    v_dot2_f32_bf16 v19, v168, v12, 0
    v_dot2_f32_bf16 v19, v169, v13, v19
    v_dot2_f32_bf16 v19, v170, v14, v19
    v_dot2_f32_bf16 v19, v171, v15, v19
    v_add_f32_dpp v20, v16, v16 row_ror:8 row_mask:0xf bank_mask:0x3
    v_add_f32_dpp v20, v17, v17 row_ror:8 row_mask:0xf bank_mask:0xc
    v_add_f32_dpp v21, v18, v18 row_ror:8 row_mask:0xf bank_mask:0x3
    v_add_f32_dpp v21, v19, v19 row_ror:8 row_mask:0xf bank_mask:0xc
    v_add_f32_dpp v36, v20, v20 row_shl:4 row_mask:0xf bank_mask:0x5
    s_nop 0
    v_add_f32_dpp v36, v21, v21 row_shr:4 row_mask:0xf bank_mask:0xa
    s_nop 1
    v_add_f32_dpp v36, v36, v36 quad_perm:[1,0,3,2] row_mask:0xf bank_mask:0xf
    s_nop 1
    v_add_f32_dpp v36, v36, v36 quad_perm:[2,3,0,1] row_mask:0xf bank_mask:0xf
    s_waitcnt vmcnt(7)
    v_dot2_f32_bf16 v16, v172, v12, 0
    v_dot2_f32_bf16 v16, v173, v13, v16
    v_dot2_f32_bf16 v16, v174, v14, v16
    v_dot2_f32_bf16 v16, v175, v15, v16
    s_waitcnt vmcnt(6)
    v_dot2_f32_bf16 v17, v176, v12, 0
    v_dot2_f32_bf16 v17, v177, v13, v17
    v_dot2_f32_bf16 v17, v178, v14, v17
    v_dot2_f32_bf16 v17, v179, v15, v17
    s_waitcnt vmcnt(5)
    v_dot2_f32_bf16 v18, v180, v12, 0
    v_dot2_f32_bf16 v18, v181, v13, v18
    v_dot2_f32_bf16 v18, v182, v14, v18
    v_dot2_f32_bf16 v18, v183, v15, v18
    s_waitcnt vmcnt(4)
    v_dot2_f32_bf16 v19, v184, v12, 0
    v_dot2_f32_bf16 v19, v185, v13, v19
    v_dot2_f32_bf16 v19, v186, v14, v19
    v_dot2_f32_bf16 v19, v187, v15, v19
    v_add_f32_dpp v20, v16, v16 row_ror:8 row_mask:0xf bank_mask:0x3
    v_add_f32_dpp v20, v17, v17 row_ror:8 row_mask:0xf bank_mask:0xc
    v_add_f32_dpp v21, v18, v18 row_ror:8 row_mask:0xf bank_mask:0x3
    v_add_f32_dpp v21, v19, v19 row_ror:8 row_mask:0xf bank_mask:0xc
    v_add_f32_dpp v37, v20, v20 row_shl:4 row_mask:0xf bank_mask:0x5
    s_nop 0
    v_add_f32_dpp v37, v21, v21 row_shr:4 row_mask:0xf bank_mask:0xa
    s_nop 1
    v_add_f32_dpp v37, v37, v37 quad_perm:[1,0,3,2] row_mask:0xf bank_mask:0xf
    s_nop 1
    v_add_f32_dpp v37, v37, v37 quad_perm:[2,3,0,1] row_mask:0xf bank_mask:0xf
    s_waitcnt vmcnt(3)
    v_dot2_f32_bf16 v16, v188, v12, 0
    v_dot2_f32_bf16 v16, v189, v13, v16
    v_dot2_f32_bf16 v16, v190, v14, v16
    v_dot2_f32_bf16 v16, v191, v15, v16
    s_add_u32 s71, s63, 98304
    buffer_load_dwordx4 v[156:159], v1, s[20:23], s71 offen offset:0 nt
    s_waitcnt vmcnt(3)
    v_dot2_f32_bf16 v17, v192, v12, 0
    v_dot2_f32_bf16 v17, v193, v13, v17
    v_dot2_f32_bf16 v17, v194, v14, v17
    v_dot2_f32_bf16 v17, v195, v15, v17
    buffer_load_dwordx4 v[160:163], v1, s[20:23], s71 offen offset:1024 nt
    s_waitcnt vmcnt(3)
    v_dot2_f32_bf16 v18, v196, v12, 0
    v_dot2_f32_bf16 v18, v197, v13, v18
    v_dot2_f32_bf16 v18, v198, v14, v18
    v_dot2_f32_bf16 v18, v199, v15, v18
    buffer_load_dwordx4 v[164:167], v1, s[20:23], s71 offen offset:2048 nt
    s_waitcnt vmcnt(3)
    v_dot2_f32_bf16 v19, v200, v12, 0
    v_dot2_f32_bf16 v19, v201, v13, v19
    v_dot2_f32_bf16 v19, v202, v14, v19
    v_dot2_f32_bf16 v19, v203, v15, v19
    buffer_load_dwordx4 v[168:171], v1, s[20:23], s71 offen offset:3072 nt
    v_add_f32_dpp v20, v16, v16 row_ror:8 row_mask:0xf bank_mask:0x3
    v_add_f32_dpp v20, v17, v17 row_ror:8 row_mask:0xf bank_mask:0xc
    v_add_f32_dpp v21, v18, v18 row_ror:8 row_mask:0xf bank_mask:0x3
    v_add_f32_dpp v21, v19, v19 row_ror:8 row_mask:0xf bank_mask:0xc
    v_add_f32_dpp v38, v20, v20 row_shl:4 row_mask:0xf bank_mask:0x5
    s_nop 0
    v_add_f32_dpp v38, v21, v21 row_shr:4 row_mask:0xf bank_mask:0xa
    s_nop 1
    v_add_f32_dpp v38, v38, v38 quad_perm:[1,0,3,2] row_mask:0xf bank_mask:0xf
    s_nop 1
    v_add_f32_dpp v38, v38, v38 quad_perm:[2,3,0,1] row_mask:0xf bank_mask:0xf
    s_waitcnt vmcnt(3)
    v_dot2_f32_bf16 v16, v156, v12, 0
    v_dot2_f32_bf16 v16, v157, v13, v16
    v_dot2_f32_bf16 v16, v158, v14, v16
    v_dot2_f32_bf16 v16, v159, v15, v16
    s_add_u32 s72, s63, 131072
    buffer_load_dwordx4 v[172:175], v1, s[20:23], s72 offen offset:0 nt
    s_waitcnt vmcnt(3)
    v_dot2_f32_bf16 v17, v160, v12, 0
    v_dot2_f32_bf16 v17, v161, v13, v17
    v_dot2_f32_bf16 v17, v162, v14, v17
    v_dot2_f32_bf16 v17, v163, v15, v17
    buffer_load_dwordx4 v[176:179], v1, s[20:23], s72 offen offset:1024 nt
    s_waitcnt vmcnt(3)
    v_dot2_f32_bf16 v18, v164, v12, 0
    v_dot2_f32_bf16 v18, v165, v13, v18
    v_dot2_f32_bf16 v18, v166, v14, v18
    v_dot2_f32_bf16 v18, v167, v15, v18
    buffer_load_dwordx4 v[180:183], v1, s[20:23], s72 offen offset:2048 nt
    s_waitcnt vmcnt(3)
    v_dot2_f32_bf16 v19, v168, v12, 0
    v_dot2_f32_bf16 v19, v169, v13, v19
    v_dot2_f32_bf16 v19, v170, v14, v19
    v_dot2_f32_bf16 v19, v171, v15, v19
    buffer_load_dwordx4 v[184:187], v1, s[20:23], s72 offen offset:3072 nt
    v_add_f32_dpp v20, v16, v16 row_ror:8 row_mask:0xf bank_mask:0x3
    v_add_f32_dpp v20, v17, v17 row_ror:8 row_mask:0xf bank_mask:0xc
    v_add_f32_dpp v21, v18, v18 row_ror:8 row_mask:0xf bank_mask:0x3
    v_add_f32_dpp v21, v19, v19 row_ror:8 row_mask:0xf bank_mask:0xc
    v_add_f32_dpp v39, v20, v20 row_shl:4 row_mask:0xf bank_mask:0x5
    s_nop 0
    v_add_f32_dpp v39, v21, v21 row_shr:4 row_mask:0xf bank_mask:0xa
    s_nop 1
    v_add_f32_dpp v39, v39, v39 quad_perm:[1,0,3,2] row_mask:0xf bank_mask:0xf
    s_nop 1
    v_add_f32_dpp v39, v39, v39 quad_perm:[2,3,0,1] row_mask:0xf bank_mask:0xf
    s_waitcnt vmcnt(3)
    v_dot2_f32_bf16 v16, v172, v12, 0
    v_dot2_f32_bf16 v16, v173, v13, v16
    v_dot2_f32_bf16 v16, v174, v14, v16
    v_dot2_f32_bf16 v16, v175, v15, v16
    s_add_u32 s73, s63, 163840
    buffer_load_dwordx4 v[188:191], v1, s[20:23], s73 offen offset:0 nt
    s_waitcnt vmcnt(3)
    v_dot2_f32_bf16 v17, v176, v12, 0
    v_dot2_f32_bf16 v17, v177, v13, v17
    v_dot2_f32_bf16 v17, v178, v14, v17
    v_dot2_f32_bf16 v17, v179, v15, v17
    buffer_load_dwordx4 v[192:195], v1, s[20:23], s73 offen offset:1024 nt
    s_waitcnt vmcnt(3)
    v_dot2_f32_bf16 v18, v180, v12, 0
    v_dot2_f32_bf16 v18, v181, v13, v18
    v_dot2_f32_bf16 v18, v182, v14, v18
    v_dot2_f32_bf16 v18, v183, v15, v18
    buffer_load_dwordx4 v[196:199], v1, s[20:23], s73 offen offset:2048 nt
    s_waitcnt vmcnt(3)
    v_dot2_f32_bf16 v19, v184, v12, 0
    v_dot2_f32_bf16 v19, v185, v13, v19
    v_dot2_f32_bf16 v19, v186, v14, v19
    v_dot2_f32_bf16 v19, v187, v15, v19
    buffer_load_dwordx4 v[200:203], v1, s[20:23], s73 offen offset:3072 nt
    v_add_f32_dpp v20, v16, v16 row_ror:8 row_mask:0xf bank_mask:0x3
    v_add_f32_dpp v20, v17, v17 row_ror:8 row_mask:0xf bank_mask:0xc
    v_add_f32_dpp v21, v18, v18 row_ror:8 row_mask:0xf bank_mask:0x3
    v_add_f32_dpp v21, v19, v19 row_ror:8 row_mask:0xf bank_mask:0xc
    v_add_f32_dpp v40, v20, v20 row_shl:4 row_mask:0xf bank_mask:0x5
    s_nop 0
    v_add_f32_dpp v40, v21, v21 row_shr:4 row_mask:0xf bank_mask:0xa
    s_nop 1
    v_add_f32_dpp v40, v40, v40 quad_perm:[1,0,3,2] row_mask:0xf bank_mask:0xf
    s_nop 1
    v_add_f32_dpp v40, v40, v40 quad_perm:[2,3,0,1] row_mask:0xf bank_mask:0xf
    s_waitcnt vmcnt(3)
    v_dot2_f32_bf16 v16, v188, v12, 0
    v_dot2_f32_bf16 v16, v189, v13, v16
    v_dot2_f32_bf16 v16, v190, v14, v16
    v_dot2_f32_bf16 v16, v191, v15, v16
    s_add_u32 s74, s63, 196608
    buffer_load_dwordx4 v[156:159], v1, s[20:23], s74 offen offset:0 nt
    s_waitcnt vmcnt(3)
    v_dot2_f32_bf16 v17, v192, v12, 0
    v_dot2_f32_bf16 v17, v193, v13, v17
    v_dot2_f32_bf16 v17, v194, v14, v17
    v_dot2_f32_bf16 v17, v195, v15, v17
    buffer_load_dwordx4 v[160:163], v1, s[20:23], s74 offen offset:1024 nt
    s_waitcnt vmcnt(3)
    v_dot2_f32_bf16 v18, v196, v12, 0
    v_dot2_f32_bf16 v18, v197, v13, v18
    v_dot2_f32_bf16 v18, v198, v14, v18
    v_dot2_f32_bf16 v18, v199, v15, v18
    buffer_load_dwordx4 v[164:167], v1, s[20:23], s74 offen offset:2048 nt
    s_waitcnt vmcnt(3)
    v_dot2_f32_bf16 v19, v200, v12, 0
    v_dot2_f32_bf16 v19, v201, v13, v19
    v_dot2_f32_bf16 v19, v202, v14, v19
    v_dot2_f32_bf16 v19, v203, v15, v19
    buffer_load_dwordx4 v[168:171], v1, s[20:23], s74 offen offset:3072 nt
    v_add_f32_dpp v20, v16, v16 row_ror:8 row_mask:0xf bank_mask:0x3
    v_add_f32_dpp v20, v17, v17 row_ror:8 row_mask:0xf bank_mask:0xc
    v_add_f32_dpp v21, v18, v18 row_ror:8 row_mask:0xf bank_mask:0x3
    v_add_f32_dpp v21, v19, v19 row_ror:8 row_mask:0xf bank_mask:0xc
    v_add_f32_dpp v41, v20, v20 row_shl:4 row_mask:0xf bank_mask:0x5
    s_nop 0
    v_add_f32_dpp v41, v21, v21 row_shr:4 row_mask:0xf bank_mask:0xa
    s_nop 1
    v_add_f32_dpp v41, v41, v41 quad_perm:[1,0,3,2] row_mask:0xf bank_mask:0xf
    s_nop 1
    v_add_f32_dpp v41, v41, v41 quad_perm:[2,3,0,1] row_mask:0xf bank_mask:0xf
    s_waitcnt vmcnt(3)
    v_dot2_f32_bf16 v16, v156, v12, 0
    v_dot2_f32_bf16 v16, v157, v13, v16
    v_dot2_f32_bf16 v16, v158, v14, v16
    v_dot2_f32_bf16 v16, v159, v15, v16
    s_add_u32 s75, s63, 229376
    buffer_load_dwordx4 v[172:175], v1, s[20:23], s75 offen offset:0 nt
    s_waitcnt vmcnt(3)
    v_dot2_f32_bf16 v17, v160, v12, 0
    v_dot2_f32_bf16 v17, v161, v13, v17
    v_dot2_f32_bf16 v17, v162, v14, v17
    v_dot2_f32_bf16 v17, v163, v15, v17
    buffer_load_dwordx4 v[176:179], v1, s[20:23], s75 offen offset:1024 nt
    s_waitcnt vmcnt(3)
    v_dot2_f32_bf16 v18, v164, v12, 0
    v_dot2_f32_bf16 v18, v165, v13, v18
    v_dot2_f32_bf16 v18, v166, v14, v18
    v_dot2_f32_bf16 v18, v167, v15, v18
    buffer_load_dwordx4 v[180:183], v1, s[20:23], s75 offen offset:2048 nt
    s_waitcnt vmcnt(3)
    v_dot2_f32_bf16 v19, v168, v12, 0
    v_dot2_f32_bf16 v19, v169, v13, v19
    v_dot2_f32_bf16 v19, v170, v14, v19
    v_dot2_f32_bf16 v19, v171, v15, v19
    buffer_load_dwordx4 v[184:187], v1, s[20:23], s75 offen offset:3072 nt
    v_add_f32_dpp v20, v16, v16 row_ror:8 row_mask:0xf bank_mask:0x3
    v_add_f32_dpp v20, v17, v17 row_ror:8 row_mask:0xf bank_mask:0xc
    v_add_f32_dpp v21, v18, v18 row_ror:8 row_mask:0xf bank_mask:0x3
    v_add_f32_dpp v21, v19, v19 row_ror:8 row_mask:0xf bank_mask:0xc
    v_add_f32_dpp v42, v20, v20 row_shl:4 row_mask:0xf bank_mask:0x5
    s_nop 0
    v_add_f32_dpp v42, v21, v21 row_shr:4 row_mask:0xf bank_mask:0xa
    s_nop 1
    v_add_f32_dpp v42, v42, v42 quad_perm:[1,0,3,2] row_mask:0xf bank_mask:0xf
    s_nop 1
    v_add_f32_dpp v42, v42, v42 quad_perm:[2,3,0,1] row_mask:0xf bank_mask:0xf
    s_waitcnt vmcnt(3)
    v_dot2_f32_bf16 v16, v172, v12, 0
    v_dot2_f32_bf16 v16, v173, v13, v16
    v_dot2_f32_bf16 v16, v174, v14, v16
    v_dot2_f32_bf16 v16, v175, v15, v16
    s_add_u32 s76, s63, 262144
    buffer_load_dwordx4 v[188:191], v1, s[20:23], s76 offen offset:0 nt
    s_waitcnt vmcnt(3)
    v_dot2_f32_bf16 v17, v176, v12, 0
    v_dot2_f32_bf16 v17, v177, v13, v17
    v_dot2_f32_bf16 v17, v178, v14, v17
    v_dot2_f32_bf16 v17, v179, v15, v17
    buffer_load_dwordx4 v[192:195], v1, s[20:23], s76 offen offset:1024 nt
    s_waitcnt vmcnt(3)
    v_dot2_f32_bf16 v18, v180, v12, 0
    v_dot2_f32_bf16 v18, v181, v13, v18
    v_dot2_f32_bf16 v18, v182, v14, v18
    v_dot2_f32_bf16 v18, v183, v15, v18
    buffer_load_dwordx4 v[196:199], v1, s[20:23], s76 offen offset:2048 nt
    s_waitcnt vmcnt(3)
    v_dot2_f32_bf16 v19, v184, v12, 0
    v_dot2_f32_bf16 v19, v185, v13, v19
    v_dot2_f32_bf16 v19, v186, v14, v19
    v_dot2_f32_bf16 v19, v187, v15, v19
    buffer_load_dwordx4 v[200:203], v1, s[20:23], s76 offen offset:3072 nt
    v_add_f32_dpp v20, v16, v16 row_ror:8 row_mask:0xf bank_mask:0x3
    v_add_f32_dpp v20, v17, v17 row_ror:8 row_mask:0xf bank_mask:0xc
    v_add_f32_dpp v21, v18, v18 row_ror:8 row_mask:0xf bank_mask:0x3
    v_add_f32_dpp v21, v19, v19 row_ror:8 row_mask:0xf bank_mask:0xc
    v_add_f32_dpp v43, v20, v20 row_shl:4 row_mask:0xf bank_mask:0x5
    s_nop 0
    v_add_f32_dpp v43, v21, v21 row_shr:4 row_mask:0xf bank_mask:0xa
    s_nop 1
    v_add_f32_dpp v43, v43, v43 quad_perm:[1,0,3,2] row_mask:0xf bank_mask:0xf
    s_nop 1
    v_add_f32_dpp v43, v43, v43 quad_perm:[2,3,0,1] row_mask:0xf bank_mask:0xf
    s_waitcnt vmcnt(3)
    v_dot2_f32_bf16 v16, v188, v12, 0
    v_dot2_f32_bf16 v16, v189, v13, v16
    v_dot2_f32_bf16 v16, v190, v14, v16
    v_dot2_f32_bf16 v16, v191, v15, v16
    s_add_u32 s77, s63, 294912
    buffer_load_dwordx4 v[156:159], v1, s[20:23], s77 offen offset:0 nt
    s_waitcnt vmcnt(3)
    v_dot2_f32_bf16 v17, v192, v12, 0
    v_dot2_f32_bf16 v17, v193, v13, v17
    v_dot2_f32_bf16 v17, v194, v14, v17
    v_dot2_f32_bf16 v17, v195, v15, v17
    buffer_load_dwordx4 v[160:163], v1, s[20:23], s77 offen offset:1024 nt
    s_waitcnt vmcnt(3)
    v_dot2_f32_bf16 v18, v196, v12, 0
    v_dot2_f32_bf16 v18, v197, v13, v18
    v_dot2_f32_bf16 v18, v198, v14, v18
    v_dot2_f32_bf16 v18, v199, v15, v18
    buffer_load_dwordx4 v[164:167], v1, s[20:23], s77 offen offset:2048 nt
    s_waitcnt vmcnt(3)
    v_dot2_f32_bf16 v19, v200, v12, 0
    v_dot2_f32_bf16 v19, v201, v13, v19
    v_dot2_f32_bf16 v19, v202, v14, v19
    v_dot2_f32_bf16 v19, v203, v15, v19
    buffer_load_dwordx4 v[168:171], v1, s[20:23], s77 offen offset:3072 nt
    v_add_f32_dpp v20, v16, v16 row_ror:8 row_mask:0xf bank_mask:0x3
    v_add_f32_dpp v20, v17, v17 row_ror:8 row_mask:0xf bank_mask:0xc
    v_add_f32_dpp v21, v18, v18 row_ror:8 row_mask:0xf bank_mask:0x3
    v_add_f32_dpp v21, v19, v19 row_ror:8 row_mask:0xf bank_mask:0xc
    v_add_f32_dpp v44, v20, v20 row_shl:4 row_mask:0xf bank_mask:0x5
    s_nop 0
    v_add_f32_dpp v44, v21, v21 row_shr:4 row_mask:0xf bank_mask:0xa
    s_nop 1
    v_add_f32_dpp v44, v44, v44 quad_perm:[1,0,3,2] row_mask:0xf bank_mask:0xf
    s_nop 1
    v_add_f32_dpp v44, v44, v44 quad_perm:[2,3,0,1] row_mask:0xf bank_mask:0xf
    s_waitcnt vmcnt(3)
    v_dot2_f32_bf16 v16, v156, v12, 0
    v_dot2_f32_bf16 v16, v157, v13, v16
    v_dot2_f32_bf16 v16, v158, v14, v16
    v_dot2_f32_bf16 v16, v159, v15, v16
    s_add_u32 s78, s63, 327680
    buffer_load_dwordx4 v[172:175], v1, s[20:23], s78 offen offset:0 nt
    s_waitcnt vmcnt(3)
    v_dot2_f32_bf16 v17, v160, v12, 0
    v_dot2_f32_bf16 v17, v161, v13, v17
    v_dot2_f32_bf16 v17, v162, v14, v17
    v_dot2_f32_bf16 v17, v163, v15, v17
    buffer_load_dwordx4 v[176:179], v1, s[20:23], s78 offen offset:1024 nt
    s_waitcnt vmcnt(3)
    v_dot2_f32_bf16 v18, v164, v12, 0
    v_dot2_f32_bf16 v18, v165, v13, v18
    v_dot2_f32_bf16 v18, v166, v14, v18
    v_dot2_f32_bf16 v18, v167, v15, v18
    buffer_load_dwordx4 v[180:183], v1, s[20:23], s78 offen offset:2048 nt
    s_waitcnt vmcnt(3)
    v_dot2_f32_bf16 v19, v168, v12, 0
    v_dot2_f32_bf16 v19, v169, v13, v19
    v_dot2_f32_bf16 v19, v170, v14, v19
    v_dot2_f32_bf16 v19, v171, v15, v19
    buffer_load_dwordx4 v[184:187], v1, s[20:23], s78 offen offset:3072 nt
    v_add_f32_dpp v20, v16, v16 row_ror:8 row_mask:0xf bank_mask:0x3
    v_add_f32_dpp v20, v17, v17 row_ror:8 row_mask:0xf bank_mask:0xc
    v_add_f32_dpp v21, v18, v18 row_ror:8 row_mask:0xf bank_mask:0x3
    v_add_f32_dpp v21, v19, v19 row_ror:8 row_mask:0xf bank_mask:0xc
    v_add_f32_dpp v45, v20, v20 row_shl:4 row_mask:0xf bank_mask:0x5
    s_nop 0
    v_add_f32_dpp v45, v21, v21 row_shr:4 row_mask:0xf bank_mask:0xa
    s_nop 1
    v_add_f32_dpp v45, v45, v45 quad_perm:[1,0,3,2] row_mask:0xf bank_mask:0xf
    s_nop 1
    v_add_f32_dpp v45, v45, v45 quad_perm:[2,3,0,1] row_mask:0xf bank_mask:0xf
    s_waitcnt vmcnt(3)
    v_dot2_f32_bf16 v16, v172, v12, 0
    v_dot2_f32_bf16 v16, v173, v13, v16
    v_dot2_f32_bf16 v16, v174, v14, v16
    v_dot2_f32_bf16 v16, v175, v15, v16
    s_add_u32 s79, s63, 360448
    buffer_load_dwordx4 v[188:191], v1, s[20:23], s79 offen offset:0 nt
    s_waitcnt vmcnt(3)
    v_dot2_f32_bf16 v17, v176, v12, 0
    v_dot2_f32_bf16 v17, v177, v13, v17
    v_dot2_f32_bf16 v17, v178, v14, v17
    v_dot2_f32_bf16 v17, v179, v15, v17
    buffer_load_dwordx4 v[192:195], v1, s[20:23], s79 offen offset:1024 nt
    s_waitcnt vmcnt(3)
    v_dot2_f32_bf16 v18, v180, v12, 0
    v_dot2_f32_bf16 v18, v181, v13, v18
    v_dot2_f32_bf16 v18, v182, v14, v18
    v_dot2_f32_bf16 v18, v183, v15, v18
    buffer_load_dwordx4 v[196:199], v1, s[20:23], s79 offen offset:2048 nt
    s_waitcnt vmcnt(3)
    v_dot2_f32_bf16 v19, v184, v12, 0
    v_dot2_f32_bf16 v19, v185, v13, v19
    v_dot2_f32_bf16 v19, v186, v14, v19
    v_dot2_f32_bf16 v19, v187, v15, v19
    buffer_load_dwordx4 v[200:203], v1, s[20:23], s79 offen offset:3072 nt
    v_add_f32_dpp v20, v16, v16 row_ror:8 row_mask:0xf bank_mask:0x3
    v_add_f32_dpp v20, v17, v17 row_ror:8 row_mask:0xf bank_mask:0xc
    v_add_f32_dpp v21, v18, v18 row_ror:8 row_mask:0xf bank_mask:0x3
    v_add_f32_dpp v21, v19, v19 row_ror:8 row_mask:0xf bank_mask:0xc
    v_add_f32_dpp v46, v20, v20 row_shl:4 row_mask:0xf bank_mask:0x5
    s_nop 0
    v_add_f32_dpp v46, v21, v21 row_shr:4 row_mask:0xf bank_mask:0xa
    s_nop 1
    v_add_f32_dpp v46, v46, v46 quad_perm:[1,0,3,2] row_mask:0xf bank_mask:0xf
    s_nop 1
    v_add_f32_dpp v46, v46, v46 quad_perm:[2,3,0,1] row_mask:0xf bank_mask:0xf
    s_waitcnt vmcnt(3)
    v_dot2_f32_bf16 v16, v188, v12, 0
    v_dot2_f32_bf16 v16, v189, v13, v16
    v_dot2_f32_bf16 v16, v190, v14, v16
    v_dot2_f32_bf16 v16, v191, v15, v16
    s_add_u32 s80, s63, 393216
    buffer_load_dwordx4 v[156:159], v1, s[20:23], s80 offen offset:0 nt
    s_waitcnt vmcnt(3)
    v_dot2_f32_bf16 v17, v192, v12, 0
    v_dot2_f32_bf16 v17, v193, v13, v17
    v_dot2_f32_bf16 v17, v194, v14, v17
    v_dot2_f32_bf16 v17, v195, v15, v17
    buffer_load_dwordx4 v[160:163], v1, s[20:23], s80 offen offset:1024 nt
    s_waitcnt vmcnt(3)
    v_dot2_f32_bf16 v18, v196, v12, 0
    v_dot2_f32_bf16 v18, v197, v13, v18
    v_dot2_f32_bf16 v18, v198, v14, v18
    v_dot2_f32_bf16 v18, v199, v15, v18
    buffer_load_dwordx4 v[164:167], v1, s[20:23], s80 offen offset:2048 nt
    s_waitcnt vmcnt(3)
    v_dot2_f32_bf16 v19, v200, v12, 0
    v_dot2_f32_bf16 v19, v201, v13, v19
    v_dot2_f32_bf16 v19, v202, v14, v19
    v_dot2_f32_bf16 v19, v203, v15, v19
    buffer_load_dwordx4 v[168:171], v1, s[20:23], s80 offen offset:3072 nt
    v_add_f32_dpp v20, v16, v16 row_ror:8 row_mask:0xf bank_mask:0x3
    v_add_f32_dpp v20, v17, v17 row_ror:8 row_mask:0xf bank_mask:0xc
    v_add_f32_dpp v21, v18, v18 row_ror:8 row_mask:0xf bank_mask:0x3
    v_add_f32_dpp v21, v19, v19 row_ror:8 row_mask:0xf bank_mask:0xc
    v_add_f32_dpp v47, v20, v20 row_shl:4 row_mask:0xf bank_mask:0x5
    s_nop 0
    v_add_f32_dpp v47, v21, v21 row_shr:4 row_mask:0xf bank_mask:0xa
    s_nop 1
    v_add_f32_dpp v47, v47, v47 quad_perm:[1,0,3,2] row_mask:0xf bank_mask:0xf
    s_nop 1
    v_add_f32_dpp v47, v47, v47 quad_perm:[2,3,0,1] row_mask:0xf bank_mask:0xf
    s_waitcnt vmcnt(3)
    v_dot2_f32_bf16 v16, v156, v12, 0
    v_dot2_f32_bf16 v16, v157, v13, v16
    v_dot2_f32_bf16 v16, v158, v14, v16
    v_dot2_f32_bf16 v16, v159, v15, v16
    s_add_u32 s81, s63, 425984
    buffer_load_dwordx4 v[172:175], v1, s[20:23], s81 offen offset:0 nt
    s_waitcnt vmcnt(3)
    v_dot2_f32_bf16 v17, v160, v12, 0
    v_dot2_f32_bf16 v17, v161, v13, v17
    v_dot2_f32_bf16 v17, v162, v14, v17
    v_dot2_f32_bf16 v17, v163, v15, v17
    buffer_load_dwordx4 v[176:179], v1, s[20:23], s81 offen offset:1024 nt
    s_waitcnt vmcnt(3)
    v_dot2_f32_bf16 v18, v164, v12, 0
    v_dot2_f32_bf16 v18, v165, v13, v18
    v_dot2_f32_bf16 v18, v166, v14, v18
    v_dot2_f32_bf16 v18, v167, v15, v18
    buffer_load_dwordx4 v[180:183], v1, s[20:23], s81 offen offset:2048 nt
    s_waitcnt vmcnt(3)
    v_dot2_f32_bf16 v19, v168, v12, 0
    v_dot2_f32_bf16 v19, v169, v13, v19
    v_dot2_f32_bf16 v19, v170, v14, v19
    v_dot2_f32_bf16 v19, v171, v15, v19
    buffer_load_dwordx4 v[184:187], v1, s[20:23], s81 offen offset:3072 nt
    v_add_f32_dpp v20, v16, v16 row_ror:8 row_mask:0xf bank_mask:0x3
    v_add_f32_dpp v20, v17, v17 row_ror:8 row_mask:0xf bank_mask:0xc
    v_add_f32_dpp v21, v18, v18 row_ror:8 row_mask:0xf bank_mask:0x3
    v_add_f32_dpp v21, v19, v19 row_ror:8 row_mask:0xf bank_mask:0xc
    v_add_f32_dpp v48, v20, v20 row_shl:4 row_mask:0xf bank_mask:0x5
    s_nop 0
    v_add_f32_dpp v48, v21, v21 row_shr:4 row_mask:0xf bank_mask:0xa
    s_nop 1
    v_add_f32_dpp v48, v48, v48 quad_perm:[1,0,3,2] row_mask:0xf bank_mask:0xf
    s_nop 1
    v_add_f32_dpp v48, v48, v48 quad_perm:[2,3,0,1] row_mask:0xf bank_mask:0xf
    s_waitcnt vmcnt(3)
    v_dot2_f32_bf16 v16, v172, v12, 0
    v_dot2_f32_bf16 v16, v173, v13, v16
    v_dot2_f32_bf16 v16, v174, v14, v16
    v_dot2_f32_bf16 v16, v175, v15, v16
    s_add_u32 s82, s63, 458752
    buffer_load_dwordx4 v[188:191], v1, s[20:23], s82 offen offset:0 nt
    s_waitcnt vmcnt(3)
    v_dot2_f32_bf16 v17, v176, v12, 0
    v_dot2_f32_bf16 v17, v177, v13, v17
    v_dot2_f32_bf16 v17, v178, v14, v17
    v_dot2_f32_bf16 v17, v179, v15, v17
    buffer_load_dwordx4 v[192:195], v1, s[20:23], s82 offen offset:1024 nt
    s_waitcnt vmcnt(3)
    v_dot2_f32_bf16 v18, v180, v12, 0
    v_dot2_f32_bf16 v18, v181, v13, v18
    v_dot2_f32_bf16 v18, v182, v14, v18
    v_dot2_f32_bf16 v18, v183, v15, v18
    buffer_load_dwordx4 v[196:199], v1, s[20:23], s82 offen offset:2048 nt
    s_waitcnt vmcnt(3)
    v_dot2_f32_bf16 v19, v184, v12, 0
    v_dot2_f32_bf16 v19, v185, v13, v19
    v_dot2_f32_bf16 v19, v186, v14, v19
    v_dot2_f32_bf16 v19, v187, v15, v19
    buffer_load_dwordx4 v[200:203], v1, s[20:23], s82 offen offset:3072 nt
    v_add_f32_dpp v20, v16, v16 row_ror:8 row_mask:0xf bank_mask:0x3
    v_add_f32_dpp v20, v17, v17 row_ror:8 row_mask:0xf bank_mask:0xc
    v_add_f32_dpp v21, v18, v18 row_ror:8 row_mask:0xf bank_mask:0x3
    v_add_f32_dpp v21, v19, v19 row_ror:8 row_mask:0xf bank_mask:0xc
    v_add_f32_dpp v49, v20, v20 row_shl:4 row_mask:0xf bank_mask:0x5
    s_nop 0
    v_add_f32_dpp v49, v21, v21 row_shr:4 row_mask:0xf bank_mask:0xa
    s_nop 1
    v_add_f32_dpp v49, v49, v49 quad_perm:[1,0,3,2] row_mask:0xf bank_mask:0xf
    s_nop 1
    v_add_f32_dpp v49, v49, v49 quad_perm:[2,3,0,1] row_mask:0xf bank_mask:0xf
    s_waitcnt vmcnt(3)
    v_dot2_f32_bf16 v16, v188, v12, 0
    v_dot2_f32_bf16 v16, v189, v13, v16
    v_dot2_f32_bf16 v16, v190, v14, v16
    v_dot2_f32_bf16 v16, v191, v15, v16
    s_add_u32 s83, s63, 491520
    buffer_load_dwordx4 v[156:159], v1, s[20:23], s83 offen offset:0 nt
    s_waitcnt vmcnt(3)
    v_dot2_f32_bf16 v17, v192, v12, 0
    v_dot2_f32_bf16 v17, v193, v13, v17
    v_dot2_f32_bf16 v17, v194, v14, v17
    v_dot2_f32_bf16 v17, v195, v15, v17
    buffer_load_dwordx4 v[160:163], v1, s[20:23], s83 offen offset:1024 nt
    s_waitcnt vmcnt(3)
    v_dot2_f32_bf16 v18, v196, v12, 0
    v_dot2_f32_bf16 v18, v197, v13, v18
    v_dot2_f32_bf16 v18, v198, v14, v18
    v_dot2_f32_bf16 v18, v199, v15, v18
    buffer_load_dwordx4 v[164:167], v1, s[20:23], s83 offen offset:2048 nt
    s_waitcnt vmcnt(3)
    v_dot2_f32_bf16 v19, v200, v12, 0
    v_dot2_f32_bf16 v19, v201, v13, v19
    v_dot2_f32_bf16 v19, v202, v14, v19
    v_dot2_f32_bf16 v19, v203, v15, v19
    buffer_load_dwordx4 v[168:171], v1, s[20:23], s83 offen offset:3072 nt
    v_add_f32_dpp v20, v16, v16 row_ror:8 row_mask:0xf bank_mask:0x3
    v_add_f32_dpp v20, v17, v17 row_ror:8 row_mask:0xf bank_mask:0xc
    v_add_f32_dpp v21, v18, v18 row_ror:8 row_mask:0xf bank_mask:0x3
    v_add_f32_dpp v21, v19, v19 row_ror:8 row_mask:0xf bank_mask:0xc
    v_add_f32_dpp v50, v20, v20 row_shl:4 row_mask:0xf bank_mask:0x5
    s_nop 0
    v_add_f32_dpp v50, v21, v21 row_shr:4 row_mask:0xf bank_mask:0xa
    s_nop 1
    v_add_f32_dpp v50, v50, v50 quad_perm:[1,0,3,2] row_mask:0xf bank_mask:0xf
    s_nop 1
    v_add_f32_dpp v50, v50, v50 quad_perm:[2,3,0,1] row_mask:0xf bank_mask:0xf
    s_waitcnt vmcnt(3)
    v_dot2_f32_bf16 v16, v156, v12, 0
    v_dot2_f32_bf16 v16, v157, v13, v16
    v_dot2_f32_bf16 v16, v158, v14, v16
    v_dot2_f32_bf16 v16, v159, v15, v16
    buffer_load_dwordx4 v[172:175], v1, s[24:27], s68 offen offset:0 nt
    s_waitcnt vmcnt(3)
    v_dot2_f32_bf16 v17, v160, v12, 0
    v_dot2_f32_bf16 v17, v161, v13, v17
    v_dot2_f32_bf16 v17, v162, v14, v17
    v_dot2_f32_bf16 v17, v163, v15, v17
    buffer_load_dwordx4 v[176:179], v1, s[24:27], s68 offen offset:1024 nt
    s_waitcnt vmcnt(3)
    v_dot2_f32_bf16 v18, v164, v12, 0
    v_dot2_f32_bf16 v18, v165, v13, v18
    v_dot2_f32_bf16 v18, v166, v14, v18
    v_dot2_f32_bf16 v18, v167, v15, v18
    buffer_load_dwordx4 v[180:183], v1, s[24:27], s68 offen offset:2048 nt
    s_waitcnt vmcnt(3)
    v_dot2_f32_bf16 v19, v168, v12, 0
    v_dot2_f32_bf16 v19, v169, v13, v19
    v_dot2_f32_bf16 v19, v170, v14, v19
    v_dot2_f32_bf16 v19, v171, v15, v19
    buffer_load_dwordx4 v[184:187], v1, s[24:27], s68 offen offset:3072 nt
    buffer_load_dwordx4 v[76:79], v3, s[32:35], s57 offen offset:0
    v_add_f32_dpp v20, v16, v16 row_ror:8 row_mask:0xf bank_mask:0x3
    v_add_f32_dpp v20, v17, v17 row_ror:8 row_mask:0xf bank_mask:0xc
    v_add_f32_dpp v21, v18, v18 row_ror:8 row_mask:0xf bank_mask:0x3
    v_add_f32_dpp v21, v19, v19 row_ror:8 row_mask:0xf bank_mask:0xc
    v_add_f32_dpp v51, v20, v20 row_shl:4 row_mask:0xf bank_mask:0x5
    s_nop 0
    v_add_f32_dpp v51, v21, v21 row_shr:4 row_mask:0xf bank_mask:0xa
    s_nop 1
    v_add_f32_dpp v51, v51, v51 quad_perm:[1,0,3,2] row_mask:0xf bank_mask:0xf
    s_nop 1
    v_add_f32_dpp v51, v51, v51 quad_perm:[2,3,0,1] row_mask:0xf bank_mask:0xf
    v_max_f32 v16, v36, v37
    v_max3_f32 v16, v16, v38, v39
    v_max3_f32 v16, v16, v40, v41
    v_max3_f32 v16, v16, v42, v43
    v_max3_f32 v16, v16, v44, v45
    v_max3_f32 v16, v16, v46, v47
    v_max3_f32 v16, v16, v48, v49
    v_max3_f32 v16, v16, v50, v51
    s_nop 1
    v_max_f32_dpp v16, v16, v16 row_ror:4 row_mask:0xf bank_mask:0xf
    s_nop 1
    v_max_f32_dpp v16, v16, v16 row_ror:8 row_mask:0xf bank_mask:0xf
    s_nop 1
    v_max_f32_dpp v16, v16, v16 row_bcast:15 row_mask:0xa bank_mask:0xf
    s_nop 1
    v_max_f32_dpp v16, v16, v16 row_bcast:31 row_mask:0xc bank_mask:0xf
    s_nop 0
    v_readlane_b32 s59, v16, 63
    v_mov_b32 v17, s58
    s_nop 0
    v_mul_f32 v17, s59, v17
    v_fma_f32 v36, v36, s58, -v17
    v_fma_f32 v37, v37, s58, -v17
    v_fma_f32 v38, v38, s58, -v17
    v_fma_f32 v39, v39, s58, -v17
    v_fma_f32 v40, v40, s58, -v17
    v_fma_f32 v41, v41, s58, -v17
    v_fma_f32 v42, v42, s58, -v17
    v_fma_f32 v43, v43, s58, -v17
    v_fma_f32 v44, v44, s58, -v17
    v_fma_f32 v45, v45, s58, -v17
    v_fma_f32 v46, v46, s58, -v17
    v_fma_f32 v47, v47, s58, -v17
    v_fma_f32 v48, v48, s58, -v17
    v_fma_f32 v49, v49, s58, -v17
    v_fma_f32 v50, v50, s58, -v17
    v_fma_f32 v51, v51, s58, -v17
    v_exp_f32 v36, v36
    v_exp_f32 v37, v37
    v_exp_f32 v38, v38
    v_exp_f32 v39, v39
    v_exp_f32 v40, v40
    v_exp_f32 v41, v41
    v_exp_f32 v42, v42
    v_exp_f32 v43, v43
    v_exp_f32 v44, v44
    v_exp_f32 v45, v45
    v_exp_f32 v46, v46
    v_exp_f32 v47, v47
    v_exp_f32 v48, v48
    v_exp_f32 v49, v49
    v_exp_f32 v50, v50
    v_exp_f32 v51, v51
    v_add_f32 v18, v36, v37
    v_add_f32 v18, v18, v38
    v_add_f32 v18, v18, v39
    v_add_f32 v18, v18, v40
    v_add_f32 v18, v18, v41
    v_add_f32 v18, v18, v42
    v_add_f32 v18, v18, v43
    v_add_f32 v18, v18, v44
    v_add_f32 v18, v18, v45
    v_add_f32 v18, v18, v46
    v_add_f32 v18, v18, v47
    v_add_f32 v18, v18, v48
    v_add_f32 v18, v18, v49
    v_add_f32 v18, v18, v50
    v_add_f32 v18, v18, v51
    s_nop 1
    v_add_f32_dpp v18, v18, v18 row_ror:4 row_mask:0xf bank_mask:0xf
    s_nop 1
    v_add_f32_dpp v18, v18, v18 row_ror:8 row_mask:0xf bank_mask:0xf
    s_nop 1
    v_add_f32_dpp v18, v18, v18 row_bcast:15 row_mask:0xa bank_mask:0xf
    s_nop 1
    v_add_f32_dpp v18, v18, v18 row_bcast:31 row_mask:0xc bank_mask:0xf
    s_lshl_b32 s54, s48, 3
    v_mov_b32 v22, s54
    s_mov_b32 exec_lo, 0
    s_mov_b32 exec_hi, 0x80000000
    ds_write_b32 v22, v17 offset:8192
    ds_write_b32 v22, v18 offset:8196
    s_mov_b64 exec, -1
    v_mov_b32 v23, 0
    s_waitcnt lgkmcnt(0)
    s_barrier
    ds_read_b128 v[52:55], v23 offset:8192
    ds_read_b128 v[56:59], v23 offset:8208
    ds_read_b128 v[60:63], v23 offset:8224
    ds_read_b128 v[64:67], v23 offset:8240
    s_waitcnt lgkmcnt(0)
    v_max_f32 v16, v52, v54
    v_max3_f32 v16, v16, v56, v58
    v_max3_f32 v16, v16, v60, v62
    v_max3_f32 v16, v16, v64, v66
    v_sub_f32 v52, v52, v16
    v_sub_f32 v54, v54, v16
    v_sub_f32 v56, v56, v16
    v_sub_f32 v58, v58, v16
    v_sub_f32 v60, v60, v16
    v_sub_f32 v62, v62, v16
    v_sub_f32 v64, v64, v16
    v_sub_f32 v66, v66, v16
    v_sub_f32 v17, v17, v16
    v_exp_f32 v52, v52
    v_exp_f32 v54, v54
    v_exp_f32 v56, v56
    v_exp_f32 v58, v58
    v_exp_f32 v60, v60
    v_exp_f32 v62, v62
    v_exp_f32 v64, v64
    v_exp_f32 v66, v66
    v_exp_f32 v17, v17
    v_mul_f32 v18, v52, v53
    v_fmac_f32 v18, v54, v55
    v_fmac_f32 v18, v56, v57
    v_fmac_f32 v18, v58, v59
    v_fmac_f32 v18, v60, v61
    v_fmac_f32 v18, v62, v63
    v_fmac_f32 v18, v64, v65
    v_fmac_f32 v18, v66, v67
    v_rcp_f32 v18, v18
    s_nop 0
    v_mul_f32 v18, v18, v17
    v_mul_f32 v36, v36, v18
    v_mul_f32 v37, v37, v18
    v_mul_f32 v38, v38, v18
    v_mul_f32 v39, v39, v18
    v_mul_f32 v40, v40, v18
    v_mul_f32 v41, v41, v18
    v_mul_f32 v42, v42, v18
    v_mul_f32 v43, v43, v18
    v_mul_f32 v44, v44, v18
    v_mul_f32 v45, v45, v18
    v_mul_f32 v46, v46, v18
    v_mul_f32 v47, v47, v18
    v_mul_f32 v48, v48, v18
    v_mul_f32 v49, v49, v18
    v_mul_f32 v50, v50, v18
    v_mul_f32 v51, v51, v18
    v_cvt_pk_bf16_f32 v36, v36, v36
    v_cvt_pk_bf16_f32 v37, v37, v37
    v_cvt_pk_bf16_f32 v38, v38, v38
    v_cvt_pk_bf16_f32 v39, v39, v39
    v_cvt_pk_bf16_f32 v40, v40, v40
    v_cvt_pk_bf16_f32 v41, v41, v41
    v_cvt_pk_bf16_f32 v42, v42, v42
    v_cvt_pk_bf16_f32 v43, v43, v43
    v_cvt_pk_bf16_f32 v44, v44, v44
    v_cvt_pk_bf16_f32 v45, v45, v45
    v_cvt_pk_bf16_f32 v46, v46, v46
    v_cvt_pk_bf16_f32 v47, v47, v47
    v_cvt_pk_bf16_f32 v48, v48, v48
    v_cvt_pk_bf16_f32 v49, v49, v49
    v_cvt_pk_bf16_f32 v50, v50, v50
    v_cvt_pk_bf16_f32 v51, v51, v51
    v_and_b32_dpp v24, v36, v4 row_newbcast:0 row_mask:0xf bank_mask:0xf
    v_and_b32_dpp v25, v36, v5 row_newbcast:0 row_mask:0xf bank_mask:0xf
    v_and_b32_dpp v26, v36, v6 row_newbcast:0 row_mask:0xf bank_mask:0xf
    v_and_b32_dpp v27, v36, v7 row_newbcast:0 row_mask:0xf bank_mask:0xf
    s_waitcnt vmcnt(4)
    s_nop 0
    v_mfma_f32_16x16x32_bf16 v[32:35], v[172:175], v[24:27], 0
    buffer_load_dwordx4 v[188:191], v1, s[24:27], s69 offen offset:0 nt
    buffer_load_dwordx4 v[80:83], v3, s[32:35], s57 offen offset:256
    v_and_b32_dpp v28, v36, v4 row_newbcast:8 row_mask:0xf bank_mask:0xf
    v_and_b32_dpp v29, v36, v5 row_newbcast:8 row_mask:0xf bank_mask:0xf
    v_and_b32_dpp v30, v36, v6 row_newbcast:8 row_mask:0xf bank_mask:0xf
    v_and_b32_dpp v31, v36, v7 row_newbcast:8 row_mask:0xf bank_mask:0xf
    s_waitcnt vmcnt(5)
    s_nop 0
    v_mfma_f32_16x16x32_bf16 v[32:35], v[176:179], v[28:31], v[32:35]
    buffer_load_dwordx4 v[192:195], v1, s[24:27], s69 offen offset:1024 nt
    buffer_load_dwordx4 v[84:87], v3, s[32:35], s57 offen offset:512
    v_and_b32_dpp v24, v36, v4 row_newbcast:4 row_mask:0xf bank_mask:0xf
    v_and_b32_dpp v25, v36, v5 row_newbcast:4 row_mask:0xf bank_mask:0xf
    v_and_b32_dpp v26, v36, v6 row_newbcast:4 row_mask:0xf bank_mask:0xf
    v_and_b32_dpp v27, v36, v7 row_newbcast:4 row_mask:0xf bank_mask:0xf
    s_waitcnt vmcnt(6)
    s_nop 0
    v_mfma_f32_16x16x32_bf16 v[32:35], v[180:183], v[24:27], v[32:35]
    buffer_load_dwordx4 v[196:199], v1, s[24:27], s69 offen offset:2048 nt
    buffer_load_dwordx4 v[88:91], v3, s[32:35], s57 offen offset:768
    v_and_b32_dpp v28, v36, v4 row_newbcast:12 row_mask:0xf bank_mask:0xf
    v_and_b32_dpp v29, v36, v5 row_newbcast:12 row_mask:0xf bank_mask:0xf
    v_and_b32_dpp v30, v36, v6 row_newbcast:12 row_mask:0xf bank_mask:0xf
    v_and_b32_dpp v31, v36, v7 row_newbcast:12 row_mask:0xf bank_mask:0xf
    s_waitcnt vmcnt(7)
    s_nop 0
    v_mfma_f32_16x16x32_bf16 v[32:35], v[184:187], v[28:31], v[32:35]
    buffer_load_dwordx4 v[200:203], v1, s[24:27], s69 offen offset:3072 nt
    buffer_load_dwordx4 v[92:95], v3, s[32:35], s57 offen offset:1024
    v_and_b32_dpp v24, v37, v4 row_newbcast:0 row_mask:0xf bank_mask:0xf
    v_and_b32_dpp v25, v37, v5 row_newbcast:0 row_mask:0xf bank_mask:0xf
    v_and_b32_dpp v26, v37, v6 row_newbcast:0 row_mask:0xf bank_mask:0xf
    v_and_b32_dpp v27, v37, v7 row_newbcast:0 row_mask:0xf bank_mask:0xf
    s_waitcnt vmcnt(7)
    s_nop 0
    v_mfma_f32_16x16x32_bf16 v[32:35], v[188:191], v[24:27], v[32:35]
    buffer_load_dwordx4 v[156:159], v1, s[24:27], s70 offen offset:0 nt
    s_add_u32 s57, s57, 5120
    buffer_load_dwordx4 v[96:99], v3, s[32:35], s57 offen offset:0
    v_and_b32_dpp v28, v37, v4 row_newbcast:8 row_mask:0xf bank_mask:0xf
    v_and_b32_dpp v29, v37, v5 row_newbcast:8 row_mask:0xf bank_mask:0xf
    v_and_b32_dpp v30, v37, v6 row_newbcast:8 row_mask:0xf bank_mask:0xf
    v_and_b32_dpp v31, v37, v7 row_newbcast:8 row_mask:0xf bank_mask:0xf
    s_waitcnt vmcnt(7)
    s_nop 0
    v_mfma_f32_16x16x32_bf16 v[32:35], v[192:195], v[28:31], v[32:35]
    buffer_load_dwordx4 v[160:163], v1, s[24:27], s70 offen offset:1024 nt
    buffer_load_dwordx4 v[100:103], v3, s[32:35], s57 offen offset:256
    v_and_b32_dpp v24, v37, v4 row_newbcast:4 row_mask:0xf bank_mask:0xf
    v_and_b32_dpp v25, v37, v5 row_newbcast:4 row_mask:0xf bank_mask:0xf
    v_and_b32_dpp v26, v37, v6 row_newbcast:4 row_mask:0xf bank_mask:0xf
    v_and_b32_dpp v27, v37, v7 row_newbcast:4 row_mask:0xf bank_mask:0xf
    s_waitcnt vmcnt(7)
    s_nop 0
    v_mfma_f32_16x16x32_bf16 v[32:35], v[196:199], v[24:27], v[32:35]
    buffer_load_dwordx4 v[164:167], v1, s[24:27], s70 offen offset:2048 nt
    buffer_load_dwordx4 v[104:107], v3, s[32:35], s57 offen offset:512
    v_and_b32_dpp v28, v37, v4 row_newbcast:12 row_mask:0xf bank_mask:0xf
    v_and_b32_dpp v29, v37, v5 row_newbcast:12 row_mask:0xf bank_mask:0xf
    v_and_b32_dpp v30, v37, v6 row_newbcast:12 row_mask:0xf bank_mask:0xf
    v_and_b32_dpp v31, v37, v7 row_newbcast:12 row_mask:0xf bank_mask:0xf
    s_waitcnt vmcnt(7)
    s_nop 0
    v_mfma_f32_16x16x32_bf16 v[32:35], v[200:203], v[28:31], v[32:35]
    buffer_load_dwordx4 v[168:171], v1, s[24:27], s70 offen offset:3072 nt
    buffer_load_dwordx4 v[108:111], v3, s[32:35], s57 offen offset:768
    v_and_b32_dpp v24, v38, v4 row_newbcast:0 row_mask:0xf bank_mask:0xf
    v_and_b32_dpp v25, v38, v5 row_newbcast:0 row_mask:0xf bank_mask:0xf
    v_and_b32_dpp v26, v38, v6 row_newbcast:0 row_mask:0xf bank_mask:0xf
    v_and_b32_dpp v27, v38, v7 row_newbcast:0 row_mask:0xf bank_mask:0xf
    s_waitcnt vmcnt(7)
    s_nop 0
    v_mfma_f32_16x16x32_bf16 v[32:35], v[156:159], v[24:27], v[32:35]
    buffer_load_dwordx4 v[172:175], v1, s[24:27], s71 offen offset:0 nt
    buffer_load_dwordx4 v[112:115], v3, s[32:35], s57 offen offset:1024
    v_and_b32_dpp v28, v38, v4 row_newbcast:8 row_mask:0xf bank_mask:0xf
    v_and_b32_dpp v29, v38, v5 row_newbcast:8 row_mask:0xf bank_mask:0xf
    v_and_b32_dpp v30, v38, v6 row_newbcast:8 row_mask:0xf bank_mask:0xf
    v_and_b32_dpp v31, v38, v7 row_newbcast:8 row_mask:0xf bank_mask:0xf
    s_waitcnt vmcnt(7)
    s_nop 0
    v_mfma_f32_16x16x32_bf16 v[32:35], v[160:163], v[28:31], v[32:35]
    buffer_load_dwordx4 v[176:179], v1, s[24:27], s71 offen offset:1024 nt
    s_add_u32 s57, s57, 5120
    buffer_load_dwordx4 v[116:119], v3, s[32:35], s57 offen offset:0
    v_and_b32_dpp v24, v38, v4 row_newbcast:4 row_mask:0xf bank_mask:0xf
    v_and_b32_dpp v25, v38, v5 row_newbcast:4 row_mask:0xf bank_mask:0xf
    v_and_b32_dpp v26, v38, v6 row_newbcast:4 row_mask:0xf bank_mask:0xf
    v_and_b32_dpp v27, v38, v7 row_newbcast:4 row_mask:0xf bank_mask:0xf
    s_waitcnt vmcnt(7)
    s_nop 0
    v_mfma_f32_16x16x32_bf16 v[32:35], v[164:167], v[24:27], v[32:35]
    buffer_load_dwordx4 v[180:183], v1, s[24:27], s71 offen offset:2048 nt
    buffer_load_dwordx4 v[120:123], v3, s[32:35], s57 offen offset:256
    v_and_b32_dpp v28, v38, v4 row_newbcast:12 row_mask:0xf bank_mask:0xf
    v_and_b32_dpp v29, v38, v5 row_newbcast:12 row_mask:0xf bank_mask:0xf
    v_and_b32_dpp v30, v38, v6 row_newbcast:12 row_mask:0xf bank_mask:0xf
    v_and_b32_dpp v31, v38, v7 row_newbcast:12 row_mask:0xf bank_mask:0xf
    s_waitcnt vmcnt(7)
    s_nop 0
    v_mfma_f32_16x16x32_bf16 v[32:35], v[168:171], v[28:31], v[32:35]
    buffer_load_dwordx4 v[184:187], v1, s[24:27], s71 offen offset:3072 nt
    buffer_load_dwordx4 v[124:127], v3, s[32:35], s57 offen offset:512
    v_and_b32_dpp v24, v39, v4 row_newbcast:0 row_mask:0xf bank_mask:0xf
    v_and_b32_dpp v25, v39, v5 row_newbcast:0 row_mask:0xf bank_mask:0xf
    v_and_b32_dpp v26, v39, v6 row_newbcast:0 row_mask:0xf bank_mask:0xf
    v_and_b32_dpp v27, v39, v7 row_newbcast:0 row_mask:0xf bank_mask:0xf
    s_waitcnt vmcnt(7)
    s_nop 0
    v_mfma_f32_16x16x32_bf16 v[32:35], v[172:175], v[24:27], v[32:35]
    buffer_load_dwordx4 v[188:191], v1, s[24:27], s72 offen offset:0 nt
    buffer_load_dwordx4 v[128:131], v3, s[32:35], s57 offen offset:768
    v_and_b32_dpp v28, v39, v4 row_newbcast:8 row_mask:0xf bank_mask:0xf
    v_and_b32_dpp v29, v39, v5 row_newbcast:8 row_mask:0xf bank_mask:0xf
    v_and_b32_dpp v30, v39, v6 row_newbcast:8 row_mask:0xf bank_mask:0xf
    v_and_b32_dpp v31, v39, v7 row_newbcast:8 row_mask:0xf bank_mask:0xf
    s_waitcnt vmcnt(7)
    s_nop 0
    v_mfma_f32_16x16x32_bf16 v[32:35], v[176:179], v[28:31], v[32:35]
    buffer_load_dwordx4 v[192:195], v1, s[24:27], s72 offen offset:1024 nt
    buffer_load_dwordx4 v[132:135], v3, s[32:35], s57 offen offset:1024
    v_and_b32_dpp v24, v39, v4 row_newbcast:4 row_mask:0xf bank_mask:0xf
    v_and_b32_dpp v25, v39, v5 row_newbcast:4 row_mask:0xf bank_mask:0xf
    v_and_b32_dpp v26, v39, v6 row_newbcast:4 row_mask:0xf bank_mask:0xf
    v_and_b32_dpp v27, v39, v7 row_newbcast:4 row_mask:0xf bank_mask:0xf
    s_waitcnt vmcnt(7)
    s_nop 0
    v_mfma_f32_16x16x32_bf16 v[32:35], v[180:183], v[24:27], v[32:35]
    buffer_load_dwordx4 v[196:199], v1, s[24:27], s72 offen offset:2048 nt
    s_add_u32 s57, s57, 5120
    buffer_load_dwordx4 v[136:139], v3, s[32:35], s57 offen offset:0
    v_and_b32_dpp v28, v39, v4 row_newbcast:12 row_mask:0xf bank_mask:0xf
    v_and_b32_dpp v29, v39, v5 row_newbcast:12 row_mask:0xf bank_mask:0xf
    v_and_b32_dpp v30, v39, v6 row_newbcast:12 row_mask:0xf bank_mask:0xf
    v_and_b32_dpp v31, v39, v7 row_newbcast:12 row_mask:0xf bank_mask:0xf
    s_waitcnt vmcnt(7)
    s_nop 0
    v_mfma_f32_16x16x32_bf16 v[32:35], v[184:187], v[28:31], v[32:35]
    buffer_load_dwordx4 v[200:203], v1, s[24:27], s72 offen offset:3072 nt
    buffer_load_dwordx4 v[140:143], v3, s[32:35], s57 offen offset:256
    v_and_b32_dpp v24, v40, v4 row_newbcast:0 row_mask:0xf bank_mask:0xf
    v_and_b32_dpp v25, v40, v5 row_newbcast:0 row_mask:0xf bank_mask:0xf
    v_and_b32_dpp v26, v40, v6 row_newbcast:0 row_mask:0xf bank_mask:0xf
    v_and_b32_dpp v27, v40, v7 row_newbcast:0 row_mask:0xf bank_mask:0xf
    s_waitcnt vmcnt(7)
    s_nop 0
    v_mfma_f32_16x16x32_bf16 v[32:35], v[188:191], v[24:27], v[32:35]
    buffer_load_dwordx4 v[156:159], v1, s[24:27], s73 offen offset:0 nt
    buffer_load_dwordx4 v[144:147], v3, s[32:35], s57 offen offset:512
    v_and_b32_dpp v28, v40, v4 row_newbcast:8 row_mask:0xf bank_mask:0xf
    v_and_b32_dpp v29, v40, v5 row_newbcast:8 row_mask:0xf bank_mask:0xf
    v_and_b32_dpp v30, v40, v6 row_newbcast:8 row_mask:0xf bank_mask:0xf
    v_and_b32_dpp v31, v40, v7 row_newbcast:8 row_mask:0xf bank_mask:0xf
    s_waitcnt vmcnt(7)
    s_nop 0
    v_mfma_f32_16x16x32_bf16 v[32:35], v[192:195], v[28:31], v[32:35]
    buffer_load_dwordx4 v[160:163], v1, s[24:27], s73 offen offset:1024 nt
    buffer_load_dwordx4 v[148:151], v3, s[32:35], s57 offen offset:768
    v_and_b32_dpp v24, v40, v4 row_newbcast:4 row_mask:0xf bank_mask:0xf
    v_and_b32_dpp v25, v40, v5 row_newbcast:4 row_mask:0xf bank_mask:0xf
    v_and_b32_dpp v26, v40, v6 row_newbcast:4 row_mask:0xf bank_mask:0xf
    v_and_b32_dpp v27, v40, v7 row_newbcast:4 row_mask:0xf bank_mask:0xf
    s_waitcnt vmcnt(7)
    s_nop 0
    v_mfma_f32_16x16x32_bf16 v[32:35], v[196:199], v[24:27], v[32:35]
    buffer_load_dwordx4 v[164:167], v1, s[24:27], s73 offen offset:2048 nt
    buffer_load_dwordx4 v[152:155], v3, s[32:35], s57 offen offset:1024
    v_and_b32_dpp v28, v40, v4 row_newbcast:12 row_mask:0xf bank_mask:0xf
    v_and_b32_dpp v29, v40, v5 row_newbcast:12 row_mask:0xf bank_mask:0xf
    v_and_b32_dpp v30, v40, v6 row_newbcast:12 row_mask:0xf bank_mask:0xf
    v_and_b32_dpp v31, v40, v7 row_newbcast:12 row_mask:0xf bank_mask:0xf
    s_waitcnt vmcnt(7)
    s_nop 0
    v_mfma_f32_16x16x32_bf16 v[32:35], v[200:203], v[28:31], v[32:35]
    buffer_load_dwordx4 v[168:171], v1, s[24:27], s73 offen offset:3072 nt
    v_and_b32_dpp v24, v41, v4 row_newbcast:0 row_mask:0xf bank_mask:0xf
    v_and_b32_dpp v25, v41, v5 row_newbcast:0 row_mask:0xf bank_mask:0xf
    v_and_b32_dpp v26, v41, v6 row_newbcast:0 row_mask:0xf bank_mask:0xf
    v_and_b32_dpp v27, v41, v7 row_newbcast:0 row_mask:0xf bank_mask:0xf
    s_waitcnt vmcnt(6)
    s_nop 0
    v_mfma_f32_16x16x32_bf16 v[32:35], v[156:159], v[24:27], v[32:35]
    buffer_load_dwordx4 v[172:175], v1, s[24:27], s74 offen offset:0 nt
    v_and_b32_dpp v28, v41, v4 row_newbcast:8 row_mask:0xf bank_mask:0xf
    v_and_b32_dpp v29, v41, v5 row_newbcast:8 row_mask:0xf bank_mask:0xf
    v_and_b32_dpp v30, v41, v6 row_newbcast:8 row_mask:0xf bank_mask:0xf
    v_and_b32_dpp v31, v41, v7 row_newbcast:8 row_mask:0xf bank_mask:0xf
    s_waitcnt vmcnt(5)
    s_nop 0
    v_mfma_f32_16x16x32_bf16 v[32:35], v[160:163], v[28:31], v[32:35]
    buffer_load_dwordx4 v[176:179], v1, s[24:27], s74 offen offset:1024 nt
    v_and_b32_dpp v24, v41, v4 row_newbcast:4 row_mask:0xf bank_mask:0xf
    v_and_b32_dpp v25, v41, v5 row_newbcast:4 row_mask:0xf bank_mask:0xf
    v_and_b32_dpp v26, v41, v6 row_newbcast:4 row_mask:0xf bank_mask:0xf
    v_and_b32_dpp v27, v41, v7 row_newbcast:4 row_mask:0xf bank_mask:0xf
    s_waitcnt vmcnt(4)
    s_nop 0
    v_mfma_f32_16x16x32_bf16 v[32:35], v[164:167], v[24:27], v[32:35]
    buffer_load_dwordx4 v[180:183], v1, s[24:27], s74 offen offset:2048 nt
    v_and_b32_dpp v28, v41, v4 row_newbcast:12 row_mask:0xf bank_mask:0xf
    v_and_b32_dpp v29, v41, v5 row_newbcast:12 row_mask:0xf bank_mask:0xf
    v_and_b32_dpp v30, v41, v6 row_newbcast:12 row_mask:0xf bank_mask:0xf
    v_and_b32_dpp v31, v41, v7 row_newbcast:12 row_mask:0xf bank_mask:0xf
    s_waitcnt vmcnt(3)
    s_nop 0
    v_mfma_f32_16x16x32_bf16 v[32:35], v[168:171], v[28:31], v[32:35]
    buffer_load_dwordx4 v[184:187], v1, s[24:27], s74 offen offset:3072 nt
    v_and_b32_dpp v24, v42, v4 row_newbcast:0 row_mask:0xf bank_mask:0xf
    v_and_b32_dpp v25, v42, v5 row_newbcast:0 row_mask:0xf bank_mask:0xf
    v_and_b32_dpp v26, v42, v6 row_newbcast:0 row_mask:0xf bank_mask:0xf
    v_and_b32_dpp v27, v42, v7 row_newbcast:0 row_mask:0xf bank_mask:0xf
    s_waitcnt vmcnt(3)
    s_nop 0
    v_mfma_f32_16x16x32_bf16 v[32:35], v[172:175], v[24:27], v[32:35]
    buffer_load_dwordx4 v[188:191], v1, s[24:27], s75 offen offset:0 nt
    v_and_b32_dpp v28, v42, v4 row_newbcast:8 row_mask:0xf bank_mask:0xf
    v_and_b32_dpp v29, v42, v5 row_newbcast:8 row_mask:0xf bank_mask:0xf
    v_and_b32_dpp v30, v42, v6 row_newbcast:8 row_mask:0xf bank_mask:0xf
    v_and_b32_dpp v31, v42, v7 row_newbcast:8 row_mask:0xf bank_mask:0xf
    s_waitcnt vmcnt(3)
    s_nop 0
    v_mfma_f32_16x16x32_bf16 v[32:35], v[176:179], v[28:31], v[32:35]
    buffer_load_dwordx4 v[192:195], v1, s[24:27], s75 offen offset:1024 nt
    v_and_b32_dpp v24, v42, v4 row_newbcast:4 row_mask:0xf bank_mask:0xf
    v_and_b32_dpp v25, v42, v5 row_newbcast:4 row_mask:0xf bank_mask:0xf
    v_and_b32_dpp v26, v42, v6 row_newbcast:4 row_mask:0xf bank_mask:0xf
    v_and_b32_dpp v27, v42, v7 row_newbcast:4 row_mask:0xf bank_mask:0xf
    s_waitcnt vmcnt(3)
    s_nop 0
    v_mfma_f32_16x16x32_bf16 v[32:35], v[180:183], v[24:27], v[32:35]
    buffer_load_dwordx4 v[196:199], v1, s[24:27], s75 offen offset:2048 nt
    v_and_b32_dpp v28, v42, v4 row_newbcast:12 row_mask:0xf bank_mask:0xf
    v_and_b32_dpp v29, v42, v5 row_newbcast:12 row_mask:0xf bank_mask:0xf
    v_and_b32_dpp v30, v42, v6 row_newbcast:12 row_mask:0xf bank_mask:0xf
    v_and_b32_dpp v31, v42, v7 row_newbcast:12 row_mask:0xf bank_mask:0xf
    s_waitcnt vmcnt(3)
    s_nop 0
    v_mfma_f32_16x16x32_bf16 v[32:35], v[184:187], v[28:31], v[32:35]
    buffer_load_dwordx4 v[200:203], v1, s[24:27], s75 offen offset:3072 nt
    v_and_b32_dpp v24, v43, v4 row_newbcast:0 row_mask:0xf bank_mask:0xf
    v_and_b32_dpp v25, v43, v5 row_newbcast:0 row_mask:0xf bank_mask:0xf
    v_and_b32_dpp v26, v43, v6 row_newbcast:0 row_mask:0xf bank_mask:0xf
    v_and_b32_dpp v27, v43, v7 row_newbcast:0 row_mask:0xf bank_mask:0xf
    s_waitcnt vmcnt(3)
    s_nop 0
    v_mfma_f32_16x16x32_bf16 v[32:35], v[188:191], v[24:27], v[32:35]
    buffer_load_dwordx4 v[156:159], v1, s[24:27], s76 offen offset:0 nt
    v_and_b32_dpp v28, v43, v4 row_newbcast:8 row_mask:0xf bank_mask:0xf
    v_and_b32_dpp v29, v43, v5 row_newbcast:8 row_mask:0xf bank_mask:0xf
    v_and_b32_dpp v30, v43, v6 row_newbcast:8 row_mask:0xf bank_mask:0xf
    v_and_b32_dpp v31, v43, v7 row_newbcast:8 row_mask:0xf bank_mask:0xf
    s_waitcnt vmcnt(3)
    s_nop 0
    v_mfma_f32_16x16x32_bf16 v[32:35], v[192:195], v[28:31], v[32:35]
    buffer_load_dwordx4 v[160:163], v1, s[24:27], s76 offen offset:1024 nt
    v_and_b32_dpp v24, v43, v4 row_newbcast:4 row_mask:0xf bank_mask:0xf
    v_and_b32_dpp v25, v43, v5 row_newbcast:4 row_mask:0xf bank_mask:0xf
    v_and_b32_dpp v26, v43, v6 row_newbcast:4 row_mask:0xf bank_mask:0xf
    v_and_b32_dpp v27, v43, v7 row_newbcast:4 row_mask:0xf bank_mask:0xf
    s_waitcnt vmcnt(3)
    s_nop 0
    v_mfma_f32_16x16x32_bf16 v[32:35], v[196:199], v[24:27], v[32:35]
    buffer_load_dwordx4 v[164:167], v1, s[24:27], s76 offen offset:2048 nt
    v_and_b32_dpp v28, v43, v4 row_newbcast:12 row_mask:0xf bank_mask:0xf
    v_and_b32_dpp v29, v43, v5 row_newbcast:12 row_mask:0xf bank_mask:0xf
    v_and_b32_dpp v30, v43, v6 row_newbcast:12 row_mask:0xf bank_mask:0xf
    v_and_b32_dpp v31, v43, v7 row_newbcast:12 row_mask:0xf bank_mask:0xf
    s_waitcnt vmcnt(3)
    s_nop 0
    v_mfma_f32_16x16x32_bf16 v[32:35], v[200:203], v[28:31], v[32:35]
    buffer_load_dwordx4 v[168:171], v1, s[24:27], s76 offen offset:3072 nt
    v_and_b32_dpp v24, v44, v4 row_newbcast:0 row_mask:0xf bank_mask:0xf
    v_and_b32_dpp v25, v44, v5 row_newbcast:0 row_mask:0xf bank_mask:0xf
    v_and_b32_dpp v26, v44, v6 row_newbcast:0 row_mask:0xf bank_mask:0xf
    v_and_b32_dpp v27, v44, v7 row_newbcast:0 row_mask:0xf bank_mask:0xf
    s_waitcnt vmcnt(3)
    s_nop 0
    v_mfma_f32_16x16x32_bf16 v[32:35], v[156:159], v[24:27], v[32:35]
    buffer_load_dwordx4 v[172:175], v1, s[24:27], s77 offen offset:0 nt
    v_and_b32_dpp v28, v44, v4 row_newbcast:8 row_mask:0xf bank_mask:0xf
    v_and_b32_dpp v29, v44, v5 row_newbcast:8 row_mask:0xf bank_mask:0xf
    v_and_b32_dpp v30, v44, v6 row_newbcast:8 row_mask:0xf bank_mask:0xf
    v_and_b32_dpp v31, v44, v7 row_newbcast:8 row_mask:0xf bank_mask:0xf
    s_waitcnt vmcnt(3)
    s_nop 0
    v_mfma_f32_16x16x32_bf16 v[32:35], v[160:163], v[28:31], v[32:35]
    buffer_load_dwordx4 v[176:179], v1, s[24:27], s77 offen offset:1024 nt
    v_and_b32_dpp v24, v44, v4 row_newbcast:4 row_mask:0xf bank_mask:0xf
    v_and_b32_dpp v25, v44, v5 row_newbcast:4 row_mask:0xf bank_mask:0xf
    v_and_b32_dpp v26, v44, v6 row_newbcast:4 row_mask:0xf bank_mask:0xf
    v_and_b32_dpp v27, v44, v7 row_newbcast:4 row_mask:0xf bank_mask:0xf
    s_waitcnt vmcnt(3)
    s_nop 0
    v_mfma_f32_16x16x32_bf16 v[32:35], v[164:167], v[24:27], v[32:35]
    buffer_load_dwordx4 v[180:183], v1, s[24:27], s77 offen offset:2048 nt
    v_and_b32_dpp v28, v44, v4 row_newbcast:12 row_mask:0xf bank_mask:0xf
    v_and_b32_dpp v29, v44, v5 row_newbcast:12 row_mask:0xf bank_mask:0xf
    v_and_b32_dpp v30, v44, v6 row_newbcast:12 row_mask:0xf bank_mask:0xf
    v_and_b32_dpp v31, v44, v7 row_newbcast:12 row_mask:0xf bank_mask:0xf
    s_waitcnt vmcnt(3)
    s_nop 0
    v_mfma_f32_16x16x32_bf16 v[32:35], v[168:171], v[28:31], v[32:35]
    buffer_load_dwordx4 v[184:187], v1, s[24:27], s77 offen offset:3072 nt
    v_and_b32_dpp v24, v45, v4 row_newbcast:0 row_mask:0xf bank_mask:0xf
    v_and_b32_dpp v25, v45, v5 row_newbcast:0 row_mask:0xf bank_mask:0xf
    v_and_b32_dpp v26, v45, v6 row_newbcast:0 row_mask:0xf bank_mask:0xf
    v_and_b32_dpp v27, v45, v7 row_newbcast:0 row_mask:0xf bank_mask:0xf
    s_waitcnt vmcnt(3)
    s_nop 0
    v_mfma_f32_16x16x32_bf16 v[32:35], v[172:175], v[24:27], v[32:35]
    buffer_load_dwordx4 v[188:191], v1, s[24:27], s78 offen offset:0 nt
    v_and_b32_dpp v28, v45, v4 row_newbcast:8 row_mask:0xf bank_mask:0xf
    v_and_b32_dpp v29, v45, v5 row_newbcast:8 row_mask:0xf bank_mask:0xf
    v_and_b32_dpp v30, v45, v6 row_newbcast:8 row_mask:0xf bank_mask:0xf
    v_and_b32_dpp v31, v45, v7 row_newbcast:8 row_mask:0xf bank_mask:0xf
    s_waitcnt vmcnt(3)
    s_nop 0
    v_mfma_f32_16x16x32_bf16 v[32:35], v[176:179], v[28:31], v[32:35]
    buffer_load_dwordx4 v[192:195], v1, s[24:27], s78 offen offset:1024 nt
    v_and_b32_dpp v24, v45, v4 row_newbcast:4 row_mask:0xf bank_mask:0xf
    v_and_b32_dpp v25, v45, v5 row_newbcast:4 row_mask:0xf bank_mask:0xf
    v_and_b32_dpp v26, v45, v6 row_newbcast:4 row_mask:0xf bank_mask:0xf
    v_and_b32_dpp v27, v45, v7 row_newbcast:4 row_mask:0xf bank_mask:0xf
    s_waitcnt vmcnt(3)
    s_nop 0
    v_mfma_f32_16x16x32_bf16 v[32:35], v[180:183], v[24:27], v[32:35]
    buffer_load_dwordx4 v[196:199], v1, s[24:27], s78 offen offset:2048 nt
    v_and_b32_dpp v28, v45, v4 row_newbcast:12 row_mask:0xf bank_mask:0xf
    v_and_b32_dpp v29, v45, v5 row_newbcast:12 row_mask:0xf bank_mask:0xf
    v_and_b32_dpp v30, v45, v6 row_newbcast:12 row_mask:0xf bank_mask:0xf
    v_and_b32_dpp v31, v45, v7 row_newbcast:12 row_mask:0xf bank_mask:0xf
    s_waitcnt vmcnt(3)
    s_nop 0
    v_mfma_f32_16x16x32_bf16 v[32:35], v[184:187], v[28:31], v[32:35]
    buffer_load_dwordx4 v[200:203], v1, s[24:27], s78 offen offset:3072 nt
    v_and_b32_dpp v24, v46, v4 row_newbcast:0 row_mask:0xf bank_mask:0xf
    v_and_b32_dpp v25, v46, v5 row_newbcast:0 row_mask:0xf bank_mask:0xf
    v_and_b32_dpp v26, v46, v6 row_newbcast:0 row_mask:0xf bank_mask:0xf
    v_and_b32_dpp v27, v46, v7 row_newbcast:0 row_mask:0xf bank_mask:0xf
    s_waitcnt vmcnt(3)
    s_nop 0
    v_mfma_f32_16x16x32_bf16 v[32:35], v[188:191], v[24:27], v[32:35]
    buffer_load_dwordx4 v[156:159], v1, s[24:27], s79 offen offset:0 nt
    v_and_b32_dpp v28, v46, v4 row_newbcast:8 row_mask:0xf bank_mask:0xf
    v_and_b32_dpp v29, v46, v5 row_newbcast:8 row_mask:0xf bank_mask:0xf
    v_and_b32_dpp v30, v46, v6 row_newbcast:8 row_mask:0xf bank_mask:0xf
    v_and_b32_dpp v31, v46, v7 row_newbcast:8 row_mask:0xf bank_mask:0xf
    s_waitcnt vmcnt(3)
    s_nop 0
    v_mfma_f32_16x16x32_bf16 v[32:35], v[192:195], v[28:31], v[32:35]
    buffer_load_dwordx4 v[160:163], v1, s[24:27], s79 offen offset:1024 nt
    v_and_b32_dpp v24, v46, v4 row_newbcast:4 row_mask:0xf bank_mask:0xf
    v_and_b32_dpp v25, v46, v5 row_newbcast:4 row_mask:0xf bank_mask:0xf
    v_and_b32_dpp v26, v46, v6 row_newbcast:4 row_mask:0xf bank_mask:0xf
    v_and_b32_dpp v27, v46, v7 row_newbcast:4 row_mask:0xf bank_mask:0xf
    s_waitcnt vmcnt(3)
    s_nop 0
    v_mfma_f32_16x16x32_bf16 v[32:35], v[196:199], v[24:27], v[32:35]
    buffer_load_dwordx4 v[164:167], v1, s[24:27], s79 offen offset:2048 nt
    v_and_b32_dpp v28, v46, v4 row_newbcast:12 row_mask:0xf bank_mask:0xf
    v_and_b32_dpp v29, v46, v5 row_newbcast:12 row_mask:0xf bank_mask:0xf
    v_and_b32_dpp v30, v46, v6 row_newbcast:12 row_mask:0xf bank_mask:0xf
    v_and_b32_dpp v31, v46, v7 row_newbcast:12 row_mask:0xf bank_mask:0xf
    s_waitcnt vmcnt(3)
    s_nop 0
    v_mfma_f32_16x16x32_bf16 v[32:35], v[200:203], v[28:31], v[32:35]
    buffer_load_dwordx4 v[168:171], v1, s[24:27], s79 offen offset:3072 nt
    v_and_b32_dpp v24, v47, v4 row_newbcast:0 row_mask:0xf bank_mask:0xf
    v_and_b32_dpp v25, v47, v5 row_newbcast:0 row_mask:0xf bank_mask:0xf
    v_and_b32_dpp v26, v47, v6 row_newbcast:0 row_mask:0xf bank_mask:0xf
    v_and_b32_dpp v27, v47, v7 row_newbcast:0 row_mask:0xf bank_mask:0xf
    s_waitcnt vmcnt(3)
    s_nop 0
    v_mfma_f32_16x16x32_bf16 v[32:35], v[156:159], v[24:27], v[32:35]
    buffer_load_dwordx4 v[172:175], v1, s[24:27], s80 offen offset:0 nt
    v_and_b32_dpp v28, v47, v4 row_newbcast:8 row_mask:0xf bank_mask:0xf
    v_and_b32_dpp v29, v47, v5 row_newbcast:8 row_mask:0xf bank_mask:0xf
    v_and_b32_dpp v30, v47, v6 row_newbcast:8 row_mask:0xf bank_mask:0xf
    v_and_b32_dpp v31, v47, v7 row_newbcast:8 row_mask:0xf bank_mask:0xf
    s_waitcnt vmcnt(3)
    s_nop 0
    v_mfma_f32_16x16x32_bf16 v[32:35], v[160:163], v[28:31], v[32:35]
    buffer_load_dwordx4 v[176:179], v1, s[24:27], s80 offen offset:1024 nt
    v_and_b32_dpp v24, v47, v4 row_newbcast:4 row_mask:0xf bank_mask:0xf
    v_and_b32_dpp v25, v47, v5 row_newbcast:4 row_mask:0xf bank_mask:0xf
    v_and_b32_dpp v26, v47, v6 row_newbcast:4 row_mask:0xf bank_mask:0xf
    v_and_b32_dpp v27, v47, v7 row_newbcast:4 row_mask:0xf bank_mask:0xf
    s_waitcnt vmcnt(3)
    s_nop 0
    v_mfma_f32_16x16x32_bf16 v[32:35], v[164:167], v[24:27], v[32:35]
    buffer_load_dwordx4 v[180:183], v1, s[24:27], s80 offen offset:2048 nt
    v_and_b32_dpp v28, v47, v4 row_newbcast:12 row_mask:0xf bank_mask:0xf
    v_and_b32_dpp v29, v47, v5 row_newbcast:12 row_mask:0xf bank_mask:0xf
    v_and_b32_dpp v30, v47, v6 row_newbcast:12 row_mask:0xf bank_mask:0xf
    v_and_b32_dpp v31, v47, v7 row_newbcast:12 row_mask:0xf bank_mask:0xf
    s_waitcnt vmcnt(3)
    s_nop 0
    v_mfma_f32_16x16x32_bf16 v[32:35], v[168:171], v[28:31], v[32:35]
    buffer_load_dwordx4 v[184:187], v1, s[24:27], s80 offen offset:3072 nt
    v_and_b32_dpp v24, v48, v4 row_newbcast:0 row_mask:0xf bank_mask:0xf
    v_and_b32_dpp v25, v48, v5 row_newbcast:0 row_mask:0xf bank_mask:0xf
    v_and_b32_dpp v26, v48, v6 row_newbcast:0 row_mask:0xf bank_mask:0xf
    v_and_b32_dpp v27, v48, v7 row_newbcast:0 row_mask:0xf bank_mask:0xf
    s_waitcnt vmcnt(3)
    s_nop 0
    v_mfma_f32_16x16x32_bf16 v[32:35], v[172:175], v[24:27], v[32:35]
    buffer_load_dwordx4 v[188:191], v1, s[24:27], s81 offen offset:0 nt
    v_and_b32_dpp v28, v48, v4 row_newbcast:8 row_mask:0xf bank_mask:0xf
    v_and_b32_dpp v29, v48, v5 row_newbcast:8 row_mask:0xf bank_mask:0xf
    v_and_b32_dpp v30, v48, v6 row_newbcast:8 row_mask:0xf bank_mask:0xf
    v_and_b32_dpp v31, v48, v7 row_newbcast:8 row_mask:0xf bank_mask:0xf
    s_waitcnt vmcnt(3)
    s_nop 0
    v_mfma_f32_16x16x32_bf16 v[32:35], v[176:179], v[28:31], v[32:35]
    buffer_load_dwordx4 v[192:195], v1, s[24:27], s81 offen offset:1024 nt
    v_and_b32_dpp v24, v48, v4 row_newbcast:4 row_mask:0xf bank_mask:0xf
    v_and_b32_dpp v25, v48, v5 row_newbcast:4 row_mask:0xf bank_mask:0xf
    v_and_b32_dpp v26, v48, v6 row_newbcast:4 row_mask:0xf bank_mask:0xf
    v_and_b32_dpp v27, v48, v7 row_newbcast:4 row_mask:0xf bank_mask:0xf
    s_waitcnt vmcnt(3)
    s_nop 0
    v_mfma_f32_16x16x32_bf16 v[32:35], v[180:183], v[24:27], v[32:35]
    buffer_load_dwordx4 v[196:199], v1, s[24:27], s81 offen offset:2048 nt
    v_and_b32_dpp v28, v48, v4 row_newbcast:12 row_mask:0xf bank_mask:0xf
    v_and_b32_dpp v29, v48, v5 row_newbcast:12 row_mask:0xf bank_mask:0xf
    v_and_b32_dpp v30, v48, v6 row_newbcast:12 row_mask:0xf bank_mask:0xf
    v_and_b32_dpp v31, v48, v7 row_newbcast:12 row_mask:0xf bank_mask:0xf
    s_waitcnt vmcnt(3)
    s_nop 0
    v_mfma_f32_16x16x32_bf16 v[32:35], v[184:187], v[28:31], v[32:35]
    buffer_load_dwordx4 v[200:203], v1, s[24:27], s81 offen offset:3072 nt
    v_and_b32_dpp v24, v49, v4 row_newbcast:0 row_mask:0xf bank_mask:0xf
    v_and_b32_dpp v25, v49, v5 row_newbcast:0 row_mask:0xf bank_mask:0xf
    v_and_b32_dpp v26, v49, v6 row_newbcast:0 row_mask:0xf bank_mask:0xf
    v_and_b32_dpp v27, v49, v7 row_newbcast:0 row_mask:0xf bank_mask:0xf
    s_waitcnt vmcnt(3)
    s_nop 0
    v_mfma_f32_16x16x32_bf16 v[32:35], v[188:191], v[24:27], v[32:35]
    buffer_load_dwordx4 v[156:159], v1, s[24:27], s82 offen offset:0 nt
    v_and_b32_dpp v28, v49, v4 row_newbcast:8 row_mask:0xf bank_mask:0xf
    v_and_b32_dpp v29, v49, v5 row_newbcast:8 row_mask:0xf bank_mask:0xf
    v_and_b32_dpp v30, v49, v6 row_newbcast:8 row_mask:0xf bank_mask:0xf
    v_and_b32_dpp v31, v49, v7 row_newbcast:8 row_mask:0xf bank_mask:0xf
    s_waitcnt vmcnt(3)
    s_nop 0
    v_mfma_f32_16x16x32_bf16 v[32:35], v[192:195], v[28:31], v[32:35]
    buffer_load_dwordx4 v[160:163], v1, s[24:27], s82 offen offset:1024 nt
    v_and_b32_dpp v24, v49, v4 row_newbcast:4 row_mask:0xf bank_mask:0xf
    v_and_b32_dpp v25, v49, v5 row_newbcast:4 row_mask:0xf bank_mask:0xf
    v_and_b32_dpp v26, v49, v6 row_newbcast:4 row_mask:0xf bank_mask:0xf
    v_and_b32_dpp v27, v49, v7 row_newbcast:4 row_mask:0xf bank_mask:0xf
    s_waitcnt vmcnt(3)
    s_nop 0
    v_mfma_f32_16x16x32_bf16 v[32:35], v[196:199], v[24:27], v[32:35]
    buffer_load_dwordx4 v[164:167], v1, s[24:27], s82 offen offset:2048 nt
    v_and_b32_dpp v28, v49, v4 row_newbcast:12 row_mask:0xf bank_mask:0xf
    v_and_b32_dpp v29, v49, v5 row_newbcast:12 row_mask:0xf bank_mask:0xf
    v_and_b32_dpp v30, v49, v6 row_newbcast:12 row_mask:0xf bank_mask:0xf
    v_and_b32_dpp v31, v49, v7 row_newbcast:12 row_mask:0xf bank_mask:0xf
    s_waitcnt vmcnt(3)
    s_nop 0
    v_mfma_f32_16x16x32_bf16 v[32:35], v[200:203], v[28:31], v[32:35]
    buffer_load_dwordx4 v[168:171], v1, s[24:27], s82 offen offset:3072 nt
    v_and_b32_dpp v24, v50, v4 row_newbcast:0 row_mask:0xf bank_mask:0xf
    v_and_b32_dpp v25, v50, v5 row_newbcast:0 row_mask:0xf bank_mask:0xf
    v_and_b32_dpp v26, v50, v6 row_newbcast:0 row_mask:0xf bank_mask:0xf
    v_and_b32_dpp v27, v50, v7 row_newbcast:0 row_mask:0xf bank_mask:0xf
    s_waitcnt vmcnt(3)
    s_nop 0
    v_mfma_f32_16x16x32_bf16 v[32:35], v[156:159], v[24:27], v[32:35]
    buffer_load_dwordx4 v[172:175], v1, s[24:27], s83 offen offset:0 nt
    v_and_b32_dpp v28, v50, v4 row_newbcast:8 row_mask:0xf bank_mask:0xf
    v_and_b32_dpp v29, v50, v5 row_newbcast:8 row_mask:0xf bank_mask:0xf
    v_and_b32_dpp v30, v50, v6 row_newbcast:8 row_mask:0xf bank_mask:0xf
    v_and_b32_dpp v31, v50, v7 row_newbcast:8 row_mask:0xf bank_mask:0xf
    s_waitcnt vmcnt(3)
    s_nop 0
    v_mfma_f32_16x16x32_bf16 v[32:35], v[160:163], v[28:31], v[32:35]
    buffer_load_dwordx4 v[176:179], v1, s[24:27], s83 offen offset:1024 nt
    v_and_b32_dpp v24, v50, v4 row_newbcast:4 row_mask:0xf bank_mask:0xf
    v_and_b32_dpp v25, v50, v5 row_newbcast:4 row_mask:0xf bank_mask:0xf
    v_and_b32_dpp v26, v50, v6 row_newbcast:4 row_mask:0xf bank_mask:0xf
    v_and_b32_dpp v27, v50, v7 row_newbcast:4 row_mask:0xf bank_mask:0xf
    s_waitcnt vmcnt(3)
    s_nop 0
    v_mfma_f32_16x16x32_bf16 v[32:35], v[164:167], v[24:27], v[32:35]
    buffer_load_dwordx4 v[180:183], v1, s[24:27], s83 offen offset:2048 nt
    v_and_b32_dpp v28, v50, v4 row_newbcast:12 row_mask:0xf bank_mask:0xf
    v_and_b32_dpp v29, v50, v5 row_newbcast:12 row_mask:0xf bank_mask:0xf
    v_and_b32_dpp v30, v50, v6 row_newbcast:12 row_mask:0xf bank_mask:0xf
    v_and_b32_dpp v31, v50, v7 row_newbcast:12 row_mask:0xf bank_mask:0xf
    s_waitcnt vmcnt(3)
    s_nop 0
    v_mfma_f32_16x16x32_bf16 v[32:35], v[168:171], v[28:31], v[32:35]
    buffer_load_dwordx4 v[184:187], v1, s[24:27], s83 offen offset:3072 nt
    v_and_b32_dpp v24, v51, v4 row_newbcast:0 row_mask:0xf bank_mask:0xf
    v_and_b32_dpp v25, v51, v5 row_newbcast:0 row_mask:0xf bank_mask:0xf
    v_and_b32_dpp v26, v51, v6 row_newbcast:0 row_mask:0xf bank_mask:0xf
    v_and_b32_dpp v27, v51, v7 row_newbcast:0 row_mask:0xf bank_mask:0xf
    s_waitcnt vmcnt(3)
    s_nop 0
    v_mfma_f32_16x16x32_bf16 v[32:35], v[172:175], v[24:27], v[32:35]
    v_and_b32_dpp v28, v51, v4 row_newbcast:8 row_mask:0xf bank_mask:0xf
    v_and_b32_dpp v29, v51, v5 row_newbcast:8 row_mask:0xf bank_mask:0xf
    v_and_b32_dpp v30, v51, v6 row_newbcast:8 row_mask:0xf bank_mask:0xf
    v_and_b32_dpp v31, v51, v7 row_newbcast:8 row_mask:0xf bank_mask:0xf
    s_waitcnt vmcnt(2)
    s_nop 0
    v_mfma_f32_16x16x32_bf16 v[32:35], v[176:179], v[28:31], v[32:35]
    v_and_b32_dpp v24, v51, v4 row_newbcast:4 row_mask:0xf bank_mask:0xf
    v_and_b32_dpp v25, v51, v5 row_newbcast:4 row_mask:0xf bank_mask:0xf
    v_and_b32_dpp v26, v51, v6 row_newbcast:4 row_mask:0xf bank_mask:0xf
    v_and_b32_dpp v27, v51, v7 row_newbcast:4 row_mask:0xf bank_mask:0xf
    s_waitcnt vmcnt(1)
    s_nop 0
    v_mfma_f32_16x16x32_bf16 v[32:35], v[180:183], v[24:27], v[32:35]
    v_and_b32_dpp v28, v51, v4 row_newbcast:12 row_mask:0xf bank_mask:0xf
    v_and_b32_dpp v29, v51, v5 row_newbcast:12 row_mask:0xf bank_mask:0xf
    v_and_b32_dpp v30, v51, v6 row_newbcast:12 row_mask:0xf bank_mask:0xf
    v_and_b32_dpp v31, v51, v7 row_newbcast:12 row_mask:0xf bank_mask:0xf
    s_waitcnt vmcnt(0)
    s_nop 0
    v_mfma_f32_16x16x32_bf16 v[32:35], v[184:187], v[28:31], v[32:35]
    s_lshl_b32 s54, s48, 9
    v_add_u32 v22, s54, v73
    s_mov_b32 exec_lo, 0x00ff00ff
    s_mov_b32 exec_hi, 0x00ff00ff
    s_nop 3
    ds_write_b128 v22, v[32:35] offset:4096
    s_mov_b64 exec, -1
    v_mov_b32 v19, 0
    s_mul_i32 s54, s48, 2560
    v_add_u32 v22, s54, v73
    s_waitcnt lgkmcnt(0)
    s_barrier
    ds_read_b32 v36, v74 offset:4096
    ds_read_b32 v37, v74 offset:4608
    ds_read_b32 v38, v74 offset:5120
    ds_read_b32 v39, v74 offset:5632
    ds_read_b32 v40, v74 offset:6144
    ds_read_b32 v41, v74 offset:6656
    ds_read_b32 v42, v74 offset:7168
    ds_read_b32 v43, v74 offset:7680
    s_waitcnt lgkmcnt(0)
    v_add_f32 v36, v36, v37
    v_add_f32 v38, v38, v39
    v_add_f32 v40, v40, v41
    v_add_f32 v42, v42, v43
    v_add_f32 v36, v36, v38
    v_add_f32 v40, v40, v42
    v_add_f32 v36, v36, v40
    v_cvt_pk_bf16_f32 v36, v36, v36
    s_nop 1
    v_and_b32_dpp v24, v36, v4 row_newbcast:0 row_mask:0xf bank_mask:0xf
    v_and_b32_dpp v25, v36, v5 row_newbcast:0 row_mask:0xf bank_mask:0xf
    v_and_b32_dpp v26, v36, v6 row_newbcast:0 row_mask:0xf bank_mask:0xf
    v_and_b32_dpp v27, v36, v7 row_newbcast:0 row_mask:0xf bank_mask:0xf
    s_nop 1
    v_mfma_f32_16x16x32_bf16 v[52:55], v[76:79], v[24:27], 0
    v_and_b32_dpp v28, v36, v4 row_newbcast:1 row_mask:0xf bank_mask:0xf
    v_and_b32_dpp v29, v36, v5 row_newbcast:1 row_mask:0xf bank_mask:0xf
    v_and_b32_dpp v30, v36, v6 row_newbcast:1 row_mask:0xf bank_mask:0xf
    v_and_b32_dpp v31, v36, v7 row_newbcast:1 row_mask:0xf bank_mask:0xf
    v_mfma_f32_16x16x32_bf16 v[56:59], v[80:83], v[24:27], 0
    v_mfma_f32_16x16x32_bf16 v[60:63], v[84:87], v[24:27], 0
    v_mfma_f32_16x16x32_bf16 v[64:67], v[88:91], v[24:27], 0
    v_mfma_f32_16x16x32_bf16 v[68:71], v[92:95], v[24:27], 0
    v_mfma_f32_16x16x32_bf16 v[52:55], v[96:99], v[28:31], v[52:55]
    v_and_b32_dpp v24, v36, v4 row_newbcast:2 row_mask:0xf bank_mask:0xf
    v_and_b32_dpp v25, v36, v5 row_newbcast:2 row_mask:0xf bank_mask:0xf
    v_and_b32_dpp v26, v36, v6 row_newbcast:2 row_mask:0xf bank_mask:0xf
    v_and_b32_dpp v27, v36, v7 row_newbcast:2 row_mask:0xf bank_mask:0xf
    v_mfma_f32_16x16x32_bf16 v[56:59], v[100:103], v[28:31], v[56:59]
    v_mfma_f32_16x16x32_bf16 v[60:63], v[104:107], v[28:31], v[60:63]
    v_mfma_f32_16x16x32_bf16 v[64:67], v[108:111], v[28:31], v[64:67]
    v_mfma_f32_16x16x32_bf16 v[68:71], v[112:115], v[28:31], v[68:71]
    v_mfma_f32_16x16x32_bf16 v[52:55], v[116:119], v[24:27], v[52:55]
    v_and_b32_dpp v28, v36, v4 row_newbcast:3 row_mask:0xf bank_mask:0xf
    v_and_b32_dpp v29, v36, v5 row_newbcast:3 row_mask:0xf bank_mask:0xf
    v_and_b32_dpp v30, v36, v6 row_newbcast:3 row_mask:0xf bank_mask:0xf
    v_and_b32_dpp v31, v36, v7 row_newbcast:3 row_mask:0xf bank_mask:0xf
    v_mfma_f32_16x16x32_bf16 v[56:59], v[120:123], v[24:27], v[56:59]
    v_mfma_f32_16x16x32_bf16 v[60:63], v[124:127], v[24:27], v[60:63]
    v_mfma_f32_16x16x32_bf16 v[64:67], v[128:131], v[24:27], v[64:67]
    v_mfma_f32_16x16x32_bf16 v[68:71], v[132:135], v[24:27], v[68:71]
    v_mfma_f32_16x16x32_bf16 v[52:55], v[136:139], v[28:31], v[52:55]
    v_mfma_f32_16x16x32_bf16 v[56:59], v[140:143], v[28:31], v[56:59]
    v_mfma_f32_16x16x32_bf16 v[60:63], v[144:147], v[28:31], v[60:63]
    v_mfma_f32_16x16x32_bf16 v[64:67], v[148:151], v[28:31], v[64:67]
    v_mfma_f32_16x16x32_bf16 v[68:71], v[152:155], v[28:31], v[68:71]
    s_mov_b32 exec_lo, 0x00ff00ff
    s_mov_b32 exec_hi, 0x00ff00ff
    s_nop 1
    ds_write_b128 v22, v[52:55] offset:8448
    ds_write_b128 v22, v[56:59] offset:8960
    ds_write_b128 v22, v[60:63] offset:9472
    ds_write_b128 v22, v[64:67] offset:9984
    ds_write_b128 v22, v[68:71] offset:10496
    s_mov_b64 exec, -1
    v_lshlrev_b32 v22, 4, v0
    s_waitcnt lgkmcnt(0)
    s_barrier
    s_cmp_ge_u32 s48, 3
    s_cbranch_scc1 L_finA
    v_cmp_gt_u32 vcc, 160, v0
    s_nop 2
    s_and_saveexec_b64 s[66:67], vcc
    ds_read_b128 v[76:79], v22 offset:8448
    ds_read_b128 v[80:83], v22 offset:11008
    ds_read_b128 v[84:87], v22 offset:13568
    ds_read_b128 v[88:91], v22 offset:16128
    ds_read_b128 v[92:95], v22 offset:18688
    ds_read_b128 v[96:99], v22 offset:21248
    ds_read_b128 v[100:103], v22 offset:23808
    ds_read_b128 v[104:107], v22 offset:26368
    s_waitcnt lgkmcnt(0)
    v_add_f32 v76, v76, v80
    v_add_f32 v77, v77, v81
    v_add_f32 v78, v78, v82
    v_add_f32 v79, v79, v83
    v_add_f32 v84, v84, v88
    v_add_f32 v85, v85, v89
    v_add_f32 v86, v86, v90
    v_add_f32 v87, v87, v91
    v_add_f32 v92, v92, v96
    v_add_f32 v93, v93, v97
    v_add_f32 v94, v94, v98
    v_add_f32 v95, v95, v99
    v_add_f32 v100, v100, v104
    v_add_f32 v101, v101, v105
    v_add_f32 v102, v102, v106
    v_add_f32 v103, v103, v107
    v_add_f32 v76, v76, v84
    v_add_f32 v77, v77, v85
    v_add_f32 v78, v78, v86
    v_add_f32 v79, v79, v87
    v_add_f32 v92, v92, v100
    v_add_f32 v93, v93, v101
    v_add_f32 v94, v94, v102
    v_add_f32 v95, v95, v103
    v_add_f32 v76, v76, v92
    v_add_f32 v77, v77, v93
    v_add_f32 v78, v78, v94
    v_add_f32 v79, v79, v95
    v_mov_b32 v84, v76
    v_mov_b32 v85, v77
    v_mov_b32 v86, s14
    v_mov_b32 v87, s15
    v_mov_b32 v88, v78
    v_mov_b32 v89, v79
    v_mov_b32 v90, s14
    v_mov_b32 v91, s15
    buffer_store_dwordx4 v[84:87], v72, s[40:43], 0 offen sc1
    buffer_store_dwordx4 v[88:91], v72, s[40:43], 0 offen offset:128 sc1
    s_mov_b64 exec, -1
    s_cmp_lg_u32 s48, 0
    s_cbranch_scc1 L_finA
    s_cmp_ge_u32 s52, 20
    s_cbranch_scc1 L_finA
    v_lshlrev_b32 v73, 4, v0
    s_lshl_b32 s55, s52, 13
    v_add_u32 v73, s55, v73
    v_add_u32 v74, 4096, v73
    s_mov_b32 s53, 0
L_pollA:
    s_add_u32 s53, s53, 1
    s_cmp_gt_u32 s53, 200000
    s_cbranch_scc1 L_finA
    buffer_load_dwordx4 v[92:95], v73, s[40:43], 0 offen offset:0 sc1
    buffer_load_dwordx4 v[96:99], v73, s[40:43], 0 offen offset:1024 sc1
    buffer_load_dwordx4 v[100:103], v73, s[40:43], 0 offen offset:2048 sc1
    buffer_load_dwordx4 v[104:107], v73, s[40:43], 0 offen offset:3072 sc1
    buffer_load_dwordx4 v[108:111], v74, s[40:43], 0 offen offset:0 sc1
    buffer_load_dwordx4 v[112:115], v74, s[40:43], 0 offen offset:1024 sc1
    buffer_load_dwordx4 v[116:119], v74, s[40:43], 0 offen offset:2048 sc1
    buffer_load_dwordx4 v[120:123], v74, s[40:43], 0 offen offset:3072 sc1
    v_mov_b32 v16, 0
    s_waitcnt vmcnt(7)
    v_xor_b32 v17, s14, v94
    v_xor_b32 v18, s15, v95
    v_or3_b32 v16, v16, v17, v18
    s_waitcnt vmcnt(6)
    v_xor_b32 v17, s14, v98
    v_xor_b32 v18, s15, v99
    v_or3_b32 v16, v16, v17, v18
    s_waitcnt vmcnt(5)
    v_xor_b32 v17, s14, v102
    v_xor_b32 v18, s15, v103
    v_or3_b32 v16, v16, v17, v18
    s_waitcnt vmcnt(4)
    v_xor_b32 v17, s14, v106
    v_xor_b32 v18, s15, v107
    v_or3_b32 v16, v16, v17, v18
    s_waitcnt vmcnt(3)
    v_xor_b32 v17, s14, v110
    v_xor_b32 v18, s15, v111
    v_or3_b32 v16, v16, v17, v18
    s_waitcnt vmcnt(2)
    v_xor_b32 v17, s14, v114
    v_xor_b32 v18, s15, v115
    v_or3_b32 v16, v16, v17, v18
    s_waitcnt vmcnt(1)
    v_xor_b32 v17, s14, v118
    v_xor_b32 v18, s15, v119
    v_or3_b32 v16, v16, v17, v18
    s_waitcnt vmcnt(0)
    v_xor_b32 v17, s14, v122
    v_xor_b32 v18, s15, v123
    v_or3_b32 v16, v16, v17, v18
    v_cmp_ne_u32 vcc, 0, v16
    s_cbranch_vccnz L_pollA
    v_add_f32 v92, v92, v96
    v_add_f32 v93, v93, v97
    v_add_f32 v100, v100, v104
    v_add_f32 v101, v101, v105
    v_add_f32 v108, v108, v112
    v_add_f32 v109, v109, v113
    v_add_f32 v116, v116, v120
    v_add_f32 v117, v117, v121
    v_add_f32 v92, v92, v100
    v_add_f32 v93, v93, v101
    v_add_f32 v108, v108, v116
    v_add_f32 v109, v109, v117
    v_add_f32 v92, v92, v108
    v_add_f32 v93, v93, v109
    v_mov_b32 v96, v92
    v_mov_b32 v97, v93
    s_nop 0
    v_permlane16_swap_b32 v92, v96
    v_permlane16_swap_b32 v93, v97
    v_add_f32 v92, v92, v96
    v_add_f32 v93, v93, v97
    v_mov_b32 v96, v92
    v_mov_b32 v97, v93
    s_nop 0
    v_permlane32_swap_b32 v92, v96
    v_permlane32_swap_b32 v93, v97
    v_add_f32 v92, v92, v96
    v_add_f32 v93, v93, v97
    v_cvt_pk_bf16_f32 v92, v92, v92
    v_cvt_pk_bf16_f32 v93, v93, v93
    v_and_b32 v22, 7, v0
    v_lshlrev_b32 v22, 1, v22
    v_bfe_u32 v23, v0, 3, 1
    v_lshl_add_u32 v22, v23, 5, v22
    s_lshl_b32 s55, s52, 6
    s_mov_b64 exec, 0xffff
    buffer_store_short v92, v22, s[44:47], s55 offen offset:0
    buffer_store_short v93, v22, s[44:47], s55 offen offset:16
    s_cmp_lg_u32 s52, 0
    s_cbranch_scc1 L_finA
    s_mov_b64 exec, 1
    s_lshl_b32 s54, s60, 7
    s_add_u32 s54, s54, 1310720
    v_mov_b32 v22, s54
    v_mov_b32 v96, s14
    v_mov_b32 v97, s15
    global_store_dwordx2 v22, v[96:97], s[18:19]
L_finA:
    s_endpgm
.p2align 8
L_bodyB:
    s_mul_i32 s53, s51, 40
    s_load_dwordx8 s[4:11], s[0:1], s53
    s_load_dwordx2 s[12:13], s[0:1], s53 offset:32
    s_load_dwordx2 s[14:15], s[0:1], 80
    s_load_dwordx4 s[16:19], s[0:1], 88
    s_lshr_b32 s50, s2, 6
    s_and_b32 s52, s2, 31
    v_lshrrev_b32 v22, 6, v0
    v_and_b32 v23, 63, v0
    v_readfirstlane_b32 s48, v22
    v_lshlrev_b32 v1, 4, v23
    v_and_b32 v16, 15, v0
    v_bfe_u32 v17, v0, 4, 2
    v_lshlrev_b32 v11, 4, v16
    v_lshl_add_u32 v2, v17, 13, v11
    s_lshl_b32 s54, s52, 8
    s_mul_i32 s49, s50, 1280
    s_mov_b32 s38, 1280
    s_mov_b32 s39, 0x20000
    s_mov_b32 s31, 0x20000
    s_mov_b32 s30, 5234944
    s_mul_i32 s61, s50, 1
    s_mul_i32 s62, s48, 163840
    v_add_u32 v28, 0, v16
    v_mul_u32_u24 v29, 52, v28
    v_lshrrev_b32 v29, 8, v29
    v_mul_u32_u24 v30, 5, v29
    v_sub_u32 v30, v28, v30
    v_add_u32 v29, s61, v29
    v_and_b32 v29, 3, v29
    v_mul_u32_u24 v29, 160, v29
    v_lshl_add_u32 v29, v30, 2, v29
    v_add_u32 v29, v29, v17
    s_mul_i32 s55, s48, 20
    v_add_u32 v29, s55, v29
    v_lshlrev_b32 v24, 1, v29
    v_add_u32 v28, 16, v16
    v_mul_u32_u24 v29, 52, v28
    v_lshrrev_b32 v29, 8, v29
    v_mul_u32_u24 v30, 5, v29
    v_sub_u32 v30, v28, v30
    v_add_u32 v29, s61, v29
    v_and_b32 v29, 3, v29
    v_mul_u32_u24 v29, 160, v29
    v_lshl_add_u32 v29, v30, 2, v29
    v_add_u32 v29, v29, v17
    s_mul_i32 s55, s48, 20
    v_add_u32 v29, s55, v29
    v_lshlrev_b32 v25, 1, v29
    s_lshl_b32 s53, s50, 5
    s_add_u32 s53, s53, s52
    s_lshl_b32 s53, s53, 2
    s_add_u32 s53, s53, 3
    s_lshl_b32 s53, s53, 19
    s_mov_b32 s22, 0x80000
    s_mov_b32 s23, 0x20000
    s_lshl_b32 s63, s48, 12
    s_waitcnt lgkmcnt(0)
    s_add_u32 s28, s10, s54
    s_addc_u32 s29, s11, 0
    s_add_u32 s20, s6, s53
    s_addc_u32 s21, s7, 0
    s_add_u32 s36, s4, s49
    s_addc_u32 s37, s5, 0
    s_add_u32 s56, s61, 0
    s_and_b32 s56, s56, 3
    s_mul_i32 s56, s56, 1310720
    s_add_u32 s56, s56, s62
    buffer_load_dwordx4 v[76:79], v2, s[28:31], s56 offen
    s_add_u32 s56, s56, 32768
    buffer_load_dwordx4 v[80:83], v2, s[28:31], s56 offen
    s_add_u32 s56, s56, 32768
    buffer_load_dwordx4 v[84:87], v2, s[28:31], s56 offen
    s_add_u32 s56, s56, 32768
    buffer_load_dwordx4 v[88:91], v2, s[28:31], s56 offen
    s_add_u32 s56, s56, 32768
    buffer_load_dwordx4 v[92:95], v2, s[28:31], s56 offen
    buffer_load_ushort v8, v24, s[36:39], 0 offen
    buffer_load_ushort v9, v25, s[36:39], 0 offen
    s_cmp_ge_u32 s50, 2
    s_cbranch_scc1 L_stAB
    s_add_u32 s68, s63, 0
    buffer_load_dwordx4 v[156:159], v1, s[20:23], s68 offen offset:0 nt
    buffer_load_dwordx4 v[160:163], v1, s[20:23], s68 offen offset:1024 nt
    buffer_load_dwordx4 v[164:167], v1, s[20:23], s68 offen offset:2048 nt
    buffer_load_dwordx4 v[168:171], v1, s[20:23], s68 offen offset:3072 nt
    s_add_u32 s69, s63, 32768
    buffer_load_dwordx4 v[172:175], v1, s[20:23], s69 offen offset:0 nt
    buffer_load_dwordx4 v[176:179], v1, s[20:23], s69 offen offset:1024 nt
    buffer_load_dwordx4 v[180:183], v1, s[20:23], s69 offen offset:2048 nt
    buffer_load_dwordx4 v[184:187], v1, s[20:23], s69 offen offset:3072 nt
    s_barrier
    s_add_u32 s56, s61, 1
    s_and_b32 s56, s56, 3
    s_mul_i32 s56, s56, 1310720
    s_add_u32 s56, s56, s62
    buffer_load_dwordx4 v[96:99], v2, s[28:31], s56 offen
    s_add_u32 s56, s56, 32768
    buffer_load_dwordx4 v[100:103], v2, s[28:31], s56 offen
    s_add_u32 s56, s56, 32768
    buffer_load_dwordx4 v[104:107], v2, s[28:31], s56 offen
    s_add_u32 s56, s56, 32768
    buffer_load_dwordx4 v[108:111], v2, s[28:31], s56 offen
    s_add_u32 s56, s56, 32768
    buffer_load_dwordx4 v[112:115], v2, s[28:31], s56 offen
    s_add_u32 s56, s61, 2
    s_and_b32 s56, s56, 3
    s_mul_i32 s56, s56, 1310720
    s_add_u32 s56, s56, s62
    buffer_load_dwordx4 v[116:119], v2, s[28:31], s56 offen
    s_add_u32 s56, s56, 32768
    buffer_load_dwordx4 v[120:123], v2, s[28:31], s56 offen
    s_add_u32 s56, s56, 32768
    buffer_load_dwordx4 v[124:127], v2, s[28:31], s56 offen
    s_add_u32 s56, s56, 32768
    buffer_load_dwordx4 v[128:131], v2, s[28:31], s56 offen
    s_add_u32 s56, s56, 32768
    buffer_load_dwordx4 v[132:135], v2, s[28:31], s56 offen
    s_add_u32 s56, s61, 3
    s_and_b32 s56, s56, 3
    s_mul_i32 s56, s56, 1310720
    s_add_u32 s56, s56, s62
    buffer_load_dwordx4 v[136:139], v2, s[28:31], s56 offen
    s_add_u32 s56, s56, 32768
    buffer_load_dwordx4 v[140:143], v2, s[28:31], s56 offen
    s_add_u32 s56, s56, 32768
    buffer_load_dwordx4 v[144:147], v2, s[28:31], s56 offen
    s_add_u32 s56, s56, 32768
    buffer_load_dwordx4 v[148:151], v2, s[28:31], s56 offen
    s_add_u32 s56, s56, 32768
    buffer_load_dwordx4 v[152:155], v2, s[28:31], s56 offen
    s_mul_i32 s55, s52, 163840
    s_add_u32 s24, s8, s53
    s_addc_u32 s25, s9, 0
    s_mov_b32 s26, 0x80000
    s_mov_b32 s27, 0x20000
    s_add_u32 s32, s12, s55
    s_addc_u32 s33, s13, 0
    s_mov_b32 s34, 163840
    s_mov_b32 s35, 0x20000
    s_mul_i32 s57, s48, 20480
    v_mul_u32_u24 v3, 1280, v17
    v_add_u32 v3, v3, v11
    s_lshl_b32 s60, s51, 2
    s_add_u32 s60, s60, s50
    s_mul_i32 s54, s60, 163840
    s_add_u32 s40, s18, s54
    s_addc_u32 s41, s19, 0
    s_mov_b32 s42, 163840
    s_mov_b32 s43, 0x20000
    s_mul_i32 s54, s50, 2560
    s_mul_i32 s55, s51, 1280
    s_add_u32 s54, s54, s55
    s_add_u32 s44, s14, s54
    s_addc_u32 s45, s15, 0
    s_mov_b32 s46, 1280
    s_mov_b32 s47, 0x20000
    s_lshl_b32 s54, s60, 7
    s_add_u32 s54, s54, 1310720
    s_load_dwordx2 s[14:15], s[18:19], s54
    v_lshrrev_b32 v72, 3, v0
    v_lshlrev_b32 v72, 13, v72
    v_and_b32 v22, 7, v0
    v_lshl_add_u32 v72, v22, 4, v72
    s_lshl_b32 s54, s52, 8
    v_add_u32 v72, s54, v72
    s_barrier
    v_and_b32 v22, 1, v16
    v_lshlrev_b32 v22, 4, v22
    v_mov_b32 v23, 0xffff
    v_lshlrev_b32 v23, v22, v23
    v_lshrrev_b32 v22, 1, v16
    v_cmp_eq_u32 vcc, 0, v22
    s_nop 1
    v_cndmask_b32 v4, 0, v23, vcc
    v_cmp_eq_u32 vcc, 1, v22
    s_nop 1
    v_cndmask_b32 v5, 0, v23, vcc
    v_cmp_eq_u32 vcc, 2, v22
    s_nop 1
    v_cndmask_b32 v6, 0, v23, vcc
    v_cmp_eq_u32 vcc, 3, v22
    s_nop 1
    v_cndmask_b32 v7, 0, v23, vcc
    s_mov_b32 s58, 0x3e0293ee
    v_lshlrev_b32 v10, 7, v17
    v_lshl_add_u32 v10, v16, 2, v10
    s_lshl_b32 s54, s48, 9
    v_add_u32 v10, s54, v10
    v_lshlrev_b32 v73, 3, v17
    v_add_u32 v73, v73, v16
    v_lshlrev_b32 v73, 4, v73
    v_and_b32 v22, 3, v16
    v_lshl_add_u32 v22, v22, 2, v17
    s_lshl_b32 s54, s48, 4
    v_add_u32 v22, s54, v22
    v_lshrrev_b32 v23, 5, v22
    v_lshlrev_b32 v74, 3, v23
    v_and_b32 v23, 7, v22
    v_add_u32 v74, v74, v23
    v_lshlrev_b32 v74, 4, v74
    v_bfe_u32 v23, v22, 3, 2
    v_lshl_add_u32 v74, v23, 2, v74
    s_waitcnt vmcnt(23)
    v_lshl_or_b32 v8, v8, 16, v8
    v_lshl_or_b32 v9, v9, 16, v9
    s_nop 0
    v_and_b32_dpp v24, v8, v4 row_newbcast:0 row_mask:0xf bank_mask:0xf
    v_and_b32_dpp v25, v8, v5 row_newbcast:0 row_mask:0xf bank_mask:0xf
    v_and_b32_dpp v26, v8, v6 row_newbcast:0 row_mask:0xf bank_mask:0xf
    v_and_b32_dpp v27, v8, v7 row_newbcast:0 row_mask:0xf bank_mask:0xf
    s_nop 1
    v_mfma_f32_16x16x32_bf16 v[32:35], v[76:79], v[24:27], 0
    v_and_b32_dpp v28, v8, v4 row_newbcast:1 row_mask:0xf bank_mask:0xf
    v_and_b32_dpp v29, v8, v5 row_newbcast:1 row_mask:0xf bank_mask:0xf
    v_and_b32_dpp v30, v8, v6 row_newbcast:1 row_mask:0xf bank_mask:0xf
    v_and_b32_dpp v31, v8, v7 row_newbcast:1 row_mask:0xf bank_mask:0xf
    s_nop 1
    v_mfma_f32_16x16x32_bf16 v[32:35], v[80:83], v[28:31], v[32:35]
    v_and_b32_dpp v24, v8, v4 row_newbcast:2 row_mask:0xf bank_mask:0xf
    v_and_b32_dpp v25, v8, v5 row_newbcast:2 row_mask:0xf bank_mask:0xf
    v_and_b32_dpp v26, v8, v6 row_newbcast:2 row_mask:0xf bank_mask:0xf
    v_and_b32_dpp v27, v8, v7 row_newbcast:2 row_mask:0xf bank_mask:0xf
    s_nop 1
    v_mfma_f32_16x16x32_bf16 v[32:35], v[84:87], v[24:27], v[32:35]
    v_and_b32_dpp v28, v8, v4 row_newbcast:3 row_mask:0xf bank_mask:0xf
    v_and_b32_dpp v29, v8, v5 row_newbcast:3 row_mask:0xf bank_mask:0xf
    v_and_b32_dpp v30, v8, v6 row_newbcast:3 row_mask:0xf bank_mask:0xf
    v_and_b32_dpp v31, v8, v7 row_newbcast:3 row_mask:0xf bank_mask:0xf
    s_nop 1
    v_mfma_f32_16x16x32_bf16 v[32:35], v[88:91], v[28:31], v[32:35]
    v_and_b32_dpp v24, v8, v4 row_newbcast:4 row_mask:0xf bank_mask:0xf
    v_and_b32_dpp v25, v8, v5 row_newbcast:4 row_mask:0xf bank_mask:0xf
    v_and_b32_dpp v26, v8, v6 row_newbcast:4 row_mask:0xf bank_mask:0xf
    v_and_b32_dpp v27, v8, v7 row_newbcast:4 row_mask:0xf bank_mask:0xf
    s_nop 1
    v_mfma_f32_16x16x32_bf16 v[32:35], v[92:95], v[24:27], v[32:35]
    v_and_b32_dpp v28, v8, v4 row_newbcast:5 row_mask:0xf bank_mask:0xf
    v_and_b32_dpp v29, v8, v5 row_newbcast:5 row_mask:0xf bank_mask:0xf
    v_and_b32_dpp v30, v8, v6 row_newbcast:5 row_mask:0xf bank_mask:0xf
    v_and_b32_dpp v31, v8, v7 row_newbcast:5 row_mask:0xf bank_mask:0xf
    s_waitcnt vmcnt(14)
    s_nop 0
    v_mfma_f32_16x16x32_bf16 v[32:35], v[96:99], v[28:31], v[32:35]
    v_and_b32_dpp v24, v8, v4 row_newbcast:6 row_mask:0xf bank_mask:0xf
    v_and_b32_dpp v25, v8, v5 row_newbcast:6 row_mask:0xf bank_mask:0xf
    v_and_b32_dpp v26, v8, v6 row_newbcast:6 row_mask:0xf bank_mask:0xf
    v_and_b32_dpp v27, v8, v7 row_newbcast:6 row_mask:0xf bank_mask:0xf
    s_waitcnt vmcnt(13)
    s_nop 0
    v_mfma_f32_16x16x32_bf16 v[32:35], v[100:103], v[24:27], v[32:35]
    v_and_b32_dpp v28, v8, v4 row_newbcast:7 row_mask:0xf bank_mask:0xf
    v_and_b32_dpp v29, v8, v5 row_newbcast:7 row_mask:0xf bank_mask:0xf
    v_and_b32_dpp v30, v8, v6 row_newbcast:7 row_mask:0xf bank_mask:0xf
    v_and_b32_dpp v31, v8, v7 row_newbcast:7 row_mask:0xf bank_mask:0xf
    s_waitcnt vmcnt(12)
    s_nop 0
    v_mfma_f32_16x16x32_bf16 v[32:35], v[104:107], v[28:31], v[32:35]
    v_and_b32_dpp v24, v8, v4 row_newbcast:8 row_mask:0xf bank_mask:0xf
    v_and_b32_dpp v25, v8, v5 row_newbcast:8 row_mask:0xf bank_mask:0xf
    v_and_b32_dpp v26, v8, v6 row_newbcast:8 row_mask:0xf bank_mask:0xf
    v_and_b32_dpp v27, v8, v7 row_newbcast:8 row_mask:0xf bank_mask:0xf
    s_waitcnt vmcnt(11)
    s_nop 0
    v_mfma_f32_16x16x32_bf16 v[32:35], v[108:111], v[24:27], v[32:35]
    v_and_b32_dpp v28, v8, v4 row_newbcast:9 row_mask:0xf bank_mask:0xf
    v_and_b32_dpp v29, v8, v5 row_newbcast:9 row_mask:0xf bank_mask:0xf
    v_and_b32_dpp v30, v8, v6 row_newbcast:9 row_mask:0xf bank_mask:0xf
    v_and_b32_dpp v31, v8, v7 row_newbcast:9 row_mask:0xf bank_mask:0xf
    s_waitcnt vmcnt(10)
    s_nop 0
    v_mfma_f32_16x16x32_bf16 v[32:35], v[112:115], v[28:31], v[32:35]
    v_and_b32_dpp v24, v8, v4 row_newbcast:10 row_mask:0xf bank_mask:0xf
    v_and_b32_dpp v25, v8, v5 row_newbcast:10 row_mask:0xf bank_mask:0xf
    v_and_b32_dpp v26, v8, v6 row_newbcast:10 row_mask:0xf bank_mask:0xf
    v_and_b32_dpp v27, v8, v7 row_newbcast:10 row_mask:0xf bank_mask:0xf
    s_waitcnt vmcnt(9)
    s_nop 0
    v_mfma_f32_16x16x32_bf16 v[32:35], v[116:119], v[24:27], v[32:35]
    v_and_b32_dpp v28, v8, v4 row_newbcast:11 row_mask:0xf bank_mask:0xf
    v_and_b32_dpp v29, v8, v5 row_newbcast:11 row_mask:0xf bank_mask:0xf
    v_and_b32_dpp v30, v8, v6 row_newbcast:11 row_mask:0xf bank_mask:0xf
    v_and_b32_dpp v31, v8, v7 row_newbcast:11 row_mask:0xf bank_mask:0xf
    s_waitcnt vmcnt(8)
    s_nop 0
    v_mfma_f32_16x16x32_bf16 v[32:35], v[120:123], v[28:31], v[32:35]
    v_and_b32_dpp v24, v8, v4 row_newbcast:12 row_mask:0xf bank_mask:0xf
    v_and_b32_dpp v25, v8, v5 row_newbcast:12 row_mask:0xf bank_mask:0xf
    v_and_b32_dpp v26, v8, v6 row_newbcast:12 row_mask:0xf bank_mask:0xf
    v_and_b32_dpp v27, v8, v7 row_newbcast:12 row_mask:0xf bank_mask:0xf
    s_waitcnt vmcnt(7)
    s_nop 0
    v_mfma_f32_16x16x32_bf16 v[32:35], v[124:127], v[24:27], v[32:35]
    v_and_b32_dpp v28, v8, v4 row_newbcast:13 row_mask:0xf bank_mask:0xf
    v_and_b32_dpp v29, v8, v5 row_newbcast:13 row_mask:0xf bank_mask:0xf
    v_and_b32_dpp v30, v8, v6 row_newbcast:13 row_mask:0xf bank_mask:0xf
    v_and_b32_dpp v31, v8, v7 row_newbcast:13 row_mask:0xf bank_mask:0xf
    s_waitcnt vmcnt(6)
    s_nop 0
    v_mfma_f32_16x16x32_bf16 v[32:35], v[128:131], v[28:31], v[32:35]
    v_and_b32_dpp v24, v8, v4 row_newbcast:14 row_mask:0xf bank_mask:0xf
    v_and_b32_dpp v25, v8, v5 row_newbcast:14 row_mask:0xf bank_mask:0xf
    v_and_b32_dpp v26, v8, v6 row_newbcast:14 row_mask:0xf bank_mask:0xf
    v_and_b32_dpp v27, v8, v7 row_newbcast:14 row_mask:0xf bank_mask:0xf
    s_waitcnt vmcnt(5)
    s_nop 0
    v_mfma_f32_16x16x32_bf16 v[32:35], v[132:135], v[24:27], v[32:35]
    v_and_b32_dpp v28, v8, v4 row_newbcast:15 row_mask:0xf bank_mask:0xf
    v_and_b32_dpp v29, v8, v5 row_newbcast:15 row_mask:0xf bank_mask:0xf
    v_and_b32_dpp v30, v8, v6 row_newbcast:15 row_mask:0xf bank_mask:0xf
    v_and_b32_dpp v31, v8, v7 row_newbcast:15 row_mask:0xf bank_mask:0xf
    s_waitcnt vmcnt(4)
    s_nop 0
    v_mfma_f32_16x16x32_bf16 v[32:35], v[136:139], v[28:31], v[32:35]
    v_and_b32_dpp v24, v9, v4 row_newbcast:0 row_mask:0xf bank_mask:0xf
    v_and_b32_dpp v25, v9, v5 row_newbcast:0 row_mask:0xf bank_mask:0xf
    v_and_b32_dpp v26, v9, v6 row_newbcast:0 row_mask:0xf bank_mask:0xf
    v_and_b32_dpp v27, v9, v7 row_newbcast:0 row_mask:0xf bank_mask:0xf
    s_waitcnt vmcnt(3)
    s_nop 0
    v_mfma_f32_16x16x32_bf16 v[32:35], v[140:143], v[24:27], v[32:35]
    v_and_b32_dpp v28, v9, v4 row_newbcast:1 row_mask:0xf bank_mask:0xf
    v_and_b32_dpp v29, v9, v5 row_newbcast:1 row_mask:0xf bank_mask:0xf
    v_and_b32_dpp v30, v9, v6 row_newbcast:1 row_mask:0xf bank_mask:0xf
    v_and_b32_dpp v31, v9, v7 row_newbcast:1 row_mask:0xf bank_mask:0xf
    s_waitcnt vmcnt(2)
    s_nop 0
    v_mfma_f32_16x16x32_bf16 v[32:35], v[144:147], v[28:31], v[32:35]
    v_and_b32_dpp v24, v9, v4 row_newbcast:2 row_mask:0xf bank_mask:0xf
    v_and_b32_dpp v25, v9, v5 row_newbcast:2 row_mask:0xf bank_mask:0xf
    v_and_b32_dpp v26, v9, v6 row_newbcast:2 row_mask:0xf bank_mask:0xf
    v_and_b32_dpp v27, v9, v7 row_newbcast:2 row_mask:0xf bank_mask:0xf
    s_waitcnt vmcnt(1)
    s_nop 0
    v_mfma_f32_16x16x32_bf16 v[32:35], v[148:151], v[24:27], v[32:35]
    v_and_b32_dpp v28, v9, v4 row_newbcast:3 row_mask:0xf bank_mask:0xf
    v_and_b32_dpp v29, v9, v5 row_newbcast:3 row_mask:0xf bank_mask:0xf
    v_and_b32_dpp v30, v9, v6 row_newbcast:3 row_mask:0xf bank_mask:0xf
    v_and_b32_dpp v31, v9, v7 row_newbcast:3 row_mask:0xf bank_mask:0xf
    s_waitcnt vmcnt(0)
    s_nop 0
    v_mfma_f32_16x16x32_bf16 v[32:35], v[152:155], v[28:31], v[32:35]
    s_add_u32 s70, s63, 65536
    buffer_load_dwordx4 v[188:191], v1, s[20:23], s70 offen offset:0 nt
    buffer_load_dwordx4 v[192:195], v1, s[20:23], s70 offen offset:1024 nt
    buffer_load_dwordx4 v[196:199], v1, s[20:23], s70 offen offset:2048 nt
    buffer_load_dwordx4 v[200:203], v1, s[20:23], s70 offen offset:3072 nt
    s_branch L_stJB
L_stAB:
    s_add_u32 s68, s63, 0
    buffer_load_dwordx4 v[156:159], v1, s[20:23], s68 offen offset:0 nt
    buffer_load_dwordx4 v[160:163], v1, s[20:23], s68 offen offset:1024 nt
    s_barrier
    s_add_u32 s56, s61, 1
    s_and_b32 s56, s56, 3
    s_mul_i32 s56, s56, 1310720
    s_add_u32 s56, s56, s62
    buffer_load_dwordx4 v[96:99], v2, s[28:31], s56 offen
    s_add_u32 s56, s56, 32768
    buffer_load_dwordx4 v[100:103], v2, s[28:31], s56 offen
    s_add_u32 s56, s56, 32768
    buffer_load_dwordx4 v[104:107], v2, s[28:31], s56 offen
    s_add_u32 s56, s56, 32768
    buffer_load_dwordx4 v[108:111], v2, s[28:31], s56 offen
    s_add_u32 s56, s56, 32768
    buffer_load_dwordx4 v[112:115], v2, s[28:31], s56 offen
    s_add_u32 s56, s61, 2
    s_and_b32 s56, s56, 3
    s_mul_i32 s56, s56, 1310720
    s_add_u32 s56, s56, s62
    buffer_load_dwordx4 v[116:119], v2, s[28:31], s56 offen
    s_add_u32 s56, s56, 32768
    buffer_load_dwordx4 v[120:123], v2, s[28:31], s56 offen
    s_add_u32 s56, s56, 32768
    buffer_load_dwordx4 v[124:127], v2, s[28:31], s56 offen
    s_add_u32 s56, s56, 32768
    buffer_load_dwordx4 v[128:131], v2, s[28:31], s56 offen
    s_add_u32 s56, s56, 32768
    buffer_load_dwordx4 v[132:135], v2, s[28:31], s56 offen
    s_add_u32 s56, s61, 3
    s_and_b32 s56, s56, 3
    s_mul_i32 s56, s56, 1310720
    s_add_u32 s56, s56, s62
    buffer_load_dwordx4 v[136:139], v2, s[28:31], s56 offen
    s_add_u32 s56, s56, 32768
    buffer_load_dwordx4 v[140:143], v2, s[28:31], s56 offen
    s_add_u32 s56, s56, 32768
    buffer_load_dwordx4 v[144:147], v2, s[28:31], s56 offen
    s_add_u32 s56, s56, 32768
    buffer_load_dwordx4 v[148:151], v2, s[28:31], s56 offen
    s_add_u32 s56, s56, 32768
    buffer_load_dwordx4 v[152:155], v2, s[28:31], s56 offen
    s_mul_i32 s55, s52, 163840
    s_add_u32 s24, s8, s53
    s_addc_u32 s25, s9, 0
    s_mov_b32 s26, 0x80000
    s_mov_b32 s27, 0x20000
    s_add_u32 s32, s12, s55
    s_addc_u32 s33, s13, 0
    s_mov_b32 s34, 163840
    s_mov_b32 s35, 0x20000
    s_mul_i32 s57, s48, 20480
    v_mul_u32_u24 v3, 1280, v17
    v_add_u32 v3, v3, v11
    s_lshl_b32 s60, s51, 2
    s_add_u32 s60, s60, s50
    s_mul_i32 s54, s60, 163840
    s_add_u32 s40, s18, s54
    s_addc_u32 s41, s19, 0
    s_mov_b32 s42, 163840
    s_mov_b32 s43, 0x20000
    s_mul_i32 s54, s50, 2560
    s_mul_i32 s55, s51, 1280
    s_add_u32 s54, s54, s55
    s_add_u32 s44, s14, s54
    s_addc_u32 s45, s15, 0
    s_mov_b32 s46, 1280
    s_mov_b32 s47, 0x20000
    s_lshl_b32 s54, s60, 7
    s_add_u32 s54, s54, 1310720
    s_load_dwordx2 s[14:15], s[18:19], s54
    v_lshrrev_b32 v72, 3, v0
    v_lshlrev_b32 v72, 13, v72
    v_and_b32 v22, 7, v0
    v_lshl_add_u32 v72, v22, 4, v72
    s_lshl_b32 s54, s52, 8
    v_add_u32 v72, s54, v72
    s_barrier
    buffer_load_dwordx4 v[164:167], v1, s[20:23], s68 offen offset:2048 nt
    buffer_load_dwordx4 v[168:171], v1, s[20:23], s68 offen offset:3072 nt
    s_add_u32 s69, s63, 32768
    buffer_load_dwordx4 v[172:175], v1, s[20:23], s69 offen offset:0 nt
    buffer_load_dwordx4 v[176:179], v1, s[20:23], s69 offen offset:1024 nt
    v_and_b32 v22, 1, v16
    v_lshlrev_b32 v22, 4, v22
    v_mov_b32 v23, 0xffff
    v_lshlrev_b32 v23, v22, v23
    v_lshrrev_b32 v22, 1, v16
    v_cmp_eq_u32 vcc, 0, v22
    s_nop 1
    v_cndmask_b32 v4, 0, v23, vcc
    v_cmp_eq_u32 vcc, 1, v22
    s_nop 1
    v_cndmask_b32 v5, 0, v23, vcc
    v_cmp_eq_u32 vcc, 2, v22
    s_nop 1
    v_cndmask_b32 v6, 0, v23, vcc
    v_cmp_eq_u32 vcc, 3, v22
    s_nop 1
    v_cndmask_b32 v7, 0, v23, vcc
    s_mov_b32 s58, 0x3e0293ee
    v_lshlrev_b32 v10, 7, v17
    v_lshl_add_u32 v10, v16, 2, v10
    s_lshl_b32 s54, s48, 9
    v_add_u32 v10, s54, v10
    v_lshlrev_b32 v73, 3, v17
    v_add_u32 v73, v73, v16
    v_lshlrev_b32 v73, 4, v73
    v_and_b32 v22, 3, v16
    v_lshl_add_u32 v22, v22, 2, v17
    s_lshl_b32 s54, s48, 4
    v_add_u32 v22, s54, v22
    v_lshrrev_b32 v23, 5, v22
    v_lshlrev_b32 v74, 3, v23
    v_and_b32 v23, 7, v22
    v_add_u32 v74, v74, v23
    v_lshlrev_b32 v74, 4, v74
    v_bfe_u32 v23, v22, 3, 2
    v_lshl_add_u32 v74, v23, 2, v74
    s_waitcnt vmcnt(21)
    v_lshl_or_b32 v8, v8, 16, v8
    v_lshl_or_b32 v9, v9, 16, v9
    s_nop 0
    v_and_b32_dpp v24, v8, v4 row_newbcast:0 row_mask:0xf bank_mask:0xf
    v_and_b32_dpp v25, v8, v5 row_newbcast:0 row_mask:0xf bank_mask:0xf
    v_and_b32_dpp v26, v8, v6 row_newbcast:0 row_mask:0xf bank_mask:0xf
    v_and_b32_dpp v27, v8, v7 row_newbcast:0 row_mask:0xf bank_mask:0xf
    s_nop 1
    v_mfma_f32_16x16x32_bf16 v[32:35], v[76:79], v[24:27], 0
    v_and_b32_dpp v28, v8, v4 row_newbcast:1 row_mask:0xf bank_mask:0xf
    v_and_b32_dpp v29, v8, v5 row_newbcast:1 row_mask:0xf bank_mask:0xf
    v_and_b32_dpp v30, v8, v6 row_newbcast:1 row_mask:0xf bank_mask:0xf
    v_and_b32_dpp v31, v8, v7 row_newbcast:1 row_mask:0xf bank_mask:0xf
    s_nop 1
    v_mfma_f32_16x16x32_bf16 v[32:35], v[80:83], v[28:31], v[32:35]
    v_and_b32_dpp v24, v8, v4 row_newbcast:2 row_mask:0xf bank_mask:0xf
    v_and_b32_dpp v25, v8, v5 row_newbcast:2 row_mask:0xf bank_mask:0xf
    v_and_b32_dpp v26, v8, v6 row_newbcast:2 row_mask:0xf bank_mask:0xf
    v_and_b32_dpp v27, v8, v7 row_newbcast:2 row_mask:0xf bank_mask:0xf
    s_nop 1
    v_mfma_f32_16x16x32_bf16 v[32:35], v[84:87], v[24:27], v[32:35]
    v_and_b32_dpp v28, v8, v4 row_newbcast:3 row_mask:0xf bank_mask:0xf
    v_and_b32_dpp v29, v8, v5 row_newbcast:3 row_mask:0xf bank_mask:0xf
    v_and_b32_dpp v30, v8, v6 row_newbcast:3 row_mask:0xf bank_mask:0xf
    v_and_b32_dpp v31, v8, v7 row_newbcast:3 row_mask:0xf bank_mask:0xf
    s_nop 1
    v_mfma_f32_16x16x32_bf16 v[32:35], v[88:91], v[28:31], v[32:35]
    v_and_b32_dpp v24, v8, v4 row_newbcast:4 row_mask:0xf bank_mask:0xf
    v_and_b32_dpp v25, v8, v5 row_newbcast:4 row_mask:0xf bank_mask:0xf
    v_and_b32_dpp v26, v8, v6 row_newbcast:4 row_mask:0xf bank_mask:0xf
    v_and_b32_dpp v27, v8, v7 row_newbcast:4 row_mask:0xf bank_mask:0xf
    s_nop 1
    v_mfma_f32_16x16x32_bf16 v[32:35], v[92:95], v[24:27], v[32:35]
    v_and_b32_dpp v28, v8, v4 row_newbcast:5 row_mask:0xf bank_mask:0xf
    v_and_b32_dpp v29, v8, v5 row_newbcast:5 row_mask:0xf bank_mask:0xf
    v_and_b32_dpp v30, v8, v6 row_newbcast:5 row_mask:0xf bank_mask:0xf
    v_and_b32_dpp v31, v8, v7 row_newbcast:5 row_mask:0xf bank_mask:0xf
    s_waitcnt vmcnt(18)
    s_nop 0
    v_mfma_f32_16x16x32_bf16 v[32:35], v[96:99], v[28:31], v[32:35]
    v_and_b32_dpp v24, v8, v4 row_newbcast:6 row_mask:0xf bank_mask:0xf
    v_and_b32_dpp v25, v8, v5 row_newbcast:6 row_mask:0xf bank_mask:0xf
    v_and_b32_dpp v26, v8, v6 row_newbcast:6 row_mask:0xf bank_mask:0xf
    v_and_b32_dpp v27, v8, v7 row_newbcast:6 row_mask:0xf bank_mask:0xf
    s_waitcnt vmcnt(17)
    s_nop 0
    v_mfma_f32_16x16x32_bf16 v[32:35], v[100:103], v[24:27], v[32:35]
    v_and_b32_dpp v28, v8, v4 row_newbcast:7 row_mask:0xf bank_mask:0xf
    v_and_b32_dpp v29, v8, v5 row_newbcast:7 row_mask:0xf bank_mask:0xf
    v_and_b32_dpp v30, v8, v6 row_newbcast:7 row_mask:0xf bank_mask:0xf
    v_and_b32_dpp v31, v8, v7 row_newbcast:7 row_mask:0xf bank_mask:0xf
    s_waitcnt vmcnt(16)
    s_nop 0
    v_mfma_f32_16x16x32_bf16 v[32:35], v[104:107], v[28:31], v[32:35]
    v_and_b32_dpp v24, v8, v4 row_newbcast:8 row_mask:0xf bank_mask:0xf
    v_and_b32_dpp v25, v8, v5 row_newbcast:8 row_mask:0xf bank_mask:0xf
    v_and_b32_dpp v26, v8, v6 row_newbcast:8 row_mask:0xf bank_mask:0xf
    v_and_b32_dpp v27, v8, v7 row_newbcast:8 row_mask:0xf bank_mask:0xf
    s_waitcnt vmcnt(15)
    s_nop 0
    v_mfma_f32_16x16x32_bf16 v[32:35], v[108:111], v[24:27], v[32:35]
    v_and_b32_dpp v28, v8, v4 row_newbcast:9 row_mask:0xf bank_mask:0xf
    v_and_b32_dpp v29, v8, v5 row_newbcast:9 row_mask:0xf bank_mask:0xf
    v_and_b32_dpp v30, v8, v6 row_newbcast:9 row_mask:0xf bank_mask:0xf
    v_and_b32_dpp v31, v8, v7 row_newbcast:9 row_mask:0xf bank_mask:0xf
    s_waitcnt vmcnt(14)
    s_nop 0
    v_mfma_f32_16x16x32_bf16 v[32:35], v[112:115], v[28:31], v[32:35]
    v_and_b32_dpp v24, v8, v4 row_newbcast:10 row_mask:0xf bank_mask:0xf
    v_and_b32_dpp v25, v8, v5 row_newbcast:10 row_mask:0xf bank_mask:0xf
    v_and_b32_dpp v26, v8, v6 row_newbcast:10 row_mask:0xf bank_mask:0xf
    v_and_b32_dpp v27, v8, v7 row_newbcast:10 row_mask:0xf bank_mask:0xf
    s_waitcnt vmcnt(13)
    s_nop 0
    v_mfma_f32_16x16x32_bf16 v[32:35], v[116:119], v[24:27], v[32:35]
    v_and_b32_dpp v28, v8, v4 row_newbcast:11 row_mask:0xf bank_mask:0xf
    v_and_b32_dpp v29, v8, v5 row_newbcast:11 row_mask:0xf bank_mask:0xf
    v_and_b32_dpp v30, v8, v6 row_newbcast:11 row_mask:0xf bank_mask:0xf
    v_and_b32_dpp v31, v8, v7 row_newbcast:11 row_mask:0xf bank_mask:0xf
    s_waitcnt vmcnt(12)
    s_nop 0
    v_mfma_f32_16x16x32_bf16 v[32:35], v[120:123], v[28:31], v[32:35]
    v_and_b32_dpp v24, v8, v4 row_newbcast:12 row_mask:0xf bank_mask:0xf
    v_and_b32_dpp v25, v8, v5 row_newbcast:12 row_mask:0xf bank_mask:0xf
    v_and_b32_dpp v26, v8, v6 row_newbcast:12 row_mask:0xf bank_mask:0xf
    v_and_b32_dpp v27, v8, v7 row_newbcast:12 row_mask:0xf bank_mask:0xf
    s_waitcnt vmcnt(11)
    s_nop 0
    v_mfma_f32_16x16x32_bf16 v[32:35], v[124:127], v[24:27], v[32:35]
    v_and_b32_dpp v28, v8, v4 row_newbcast:13 row_mask:0xf bank_mask:0xf
    v_and_b32_dpp v29, v8, v5 row_newbcast:13 row_mask:0xf bank_mask:0xf
    v_and_b32_dpp v30, v8, v6 row_newbcast:13 row_mask:0xf bank_mask:0xf
    v_and_b32_dpp v31, v8, v7 row_newbcast:13 row_mask:0xf bank_mask:0xf
    s_waitcnt vmcnt(10)
    s_nop 0
    v_mfma_f32_16x16x32_bf16 v[32:35], v[128:131], v[28:31], v[32:35]
    v_and_b32_dpp v24, v8, v4 row_newbcast:14 row_mask:0xf bank_mask:0xf
    v_and_b32_dpp v25, v8, v5 row_newbcast:14 row_mask:0xf bank_mask:0xf
    v_and_b32_dpp v26, v8, v6 row_newbcast:14 row_mask:0xf bank_mask:0xf
    v_and_b32_dpp v27, v8, v7 row_newbcast:14 row_mask:0xf bank_mask:0xf
    s_waitcnt vmcnt(9)
    s_nop 0
    v_mfma_f32_16x16x32_bf16 v[32:35], v[132:135], v[24:27], v[32:35]
    v_and_b32_dpp v28, v8, v4 row_newbcast:15 row_mask:0xf bank_mask:0xf
    v_and_b32_dpp v29, v8, v5 row_newbcast:15 row_mask:0xf bank_mask:0xf
    v_and_b32_dpp v30, v8, v6 row_newbcast:15 row_mask:0xf bank_mask:0xf
    v_and_b32_dpp v31, v8, v7 row_newbcast:15 row_mask:0xf bank_mask:0xf
    s_waitcnt vmcnt(8)
    s_nop 0
    v_mfma_f32_16x16x32_bf16 v[32:35], v[136:139], v[28:31], v[32:35]
    v_and_b32_dpp v24, v9, v4 row_newbcast:0 row_mask:0xf bank_mask:0xf
    v_and_b32_dpp v25, v9, v5 row_newbcast:0 row_mask:0xf bank_mask:0xf
    v_and_b32_dpp v26, v9, v6 row_newbcast:0 row_mask:0xf bank_mask:0xf
    v_and_b32_dpp v27, v9, v7 row_newbcast:0 row_mask:0xf bank_mask:0xf
    s_waitcnt vmcnt(7)
    s_nop 0
    v_mfma_f32_16x16x32_bf16 v[32:35], v[140:143], v[24:27], v[32:35]
    v_and_b32_dpp v28, v9, v4 row_newbcast:1 row_mask:0xf bank_mask:0xf
    v_and_b32_dpp v29, v9, v5 row_newbcast:1 row_mask:0xf bank_mask:0xf
    v_and_b32_dpp v30, v9, v6 row_newbcast:1 row_mask:0xf bank_mask:0xf
    v_and_b32_dpp v31, v9, v7 row_newbcast:1 row_mask:0xf bank_mask:0xf
    s_waitcnt vmcnt(6)
    s_nop 0
    v_mfma_f32_16x16x32_bf16 v[32:35], v[144:147], v[28:31], v[32:35]
    v_and_b32_dpp v24, v9, v4 row_newbcast:2 row_mask:0xf bank_mask:0xf
    v_and_b32_dpp v25, v9, v5 row_newbcast:2 row_mask:0xf bank_mask:0xf
    v_and_b32_dpp v26, v9, v6 row_newbcast:2 row_mask:0xf bank_mask:0xf
    v_and_b32_dpp v27, v9, v7 row_newbcast:2 row_mask:0xf bank_mask:0xf
    s_waitcnt vmcnt(5)
    s_nop 0
    v_mfma_f32_16x16x32_bf16 v[32:35], v[148:151], v[24:27], v[32:35]
    v_and_b32_dpp v28, v9, v4 row_newbcast:3 row_mask:0xf bank_mask:0xf
    v_and_b32_dpp v29, v9, v5 row_newbcast:3 row_mask:0xf bank_mask:0xf
    v_and_b32_dpp v30, v9, v6 row_newbcast:3 row_mask:0xf bank_mask:0xf
    v_and_b32_dpp v31, v9, v7 row_newbcast:3 row_mask:0xf bank_mask:0xf
    s_waitcnt vmcnt(4)
    s_nop 0
    v_mfma_f32_16x16x32_bf16 v[32:35], v[152:155], v[28:31], v[32:35]
    buffer_load_dwordx4 v[180:183], v1, s[20:23], s69 offen offset:2048 nt
    buffer_load_dwordx4 v[184:187], v1, s[20:23], s69 offen offset:3072 nt
    s_add_u32 s70, s63, 65536
    buffer_load_dwordx4 v[188:191], v1, s[20:23], s70 offen offset:0 nt
    buffer_load_dwordx4 v[192:195], v1, s[20:23], s70 offen offset:1024 nt
    buffer_load_dwordx4 v[196:199], v1, s[20:23], s70 offen offset:2048 nt
    buffer_load_dwordx4 v[200:203], v1, s[20:23], s70 offen offset:3072 nt
L_stJB:
    s_nop 7
    s_mov_b32 exec_lo, 0x00ff00ff
    s_mov_b32 exec_hi, 0x00ff00ff
    ds_write_b32 v10, v32 offset:0
    ds_write_b32 v10, v33 offset:32
    ds_write_b32 v10, v34 offset:64
    ds_write_b32 v10, v35 offset:96
    s_mov_b64 exec, -1
    v_lshlrev_b32 v22, 3, v0
    v_and_b32 v22, 511, v22
    s_waitcnt lgkmcnt(0)
    s_barrier
    s_add_u32 s14, s14, 0x7f4a7c15
    s_addc_u32 s15, s15, 0x9e3779b9
    ds_read_b64 v[36:37], v22 offset:0
    ds_read_b64 v[38:39], v22 offset:512
    ds_read_b64 v[40:41], v22 offset:1024
    ds_read_b64 v[42:43], v22 offset:1536
    ds_read_b64 v[44:45], v22 offset:2048
    ds_read_b64 v[46:47], v22 offset:2560
    ds_read_b64 v[48:49], v22 offset:3072
    ds_read_b64 v[50:51], v22 offset:3584
    s_waitcnt lgkmcnt(0)
    v_add_f32 v36, v36, v38
    v_add_f32 v37, v37, v39
    v_add_f32 v36, v36, v40
    v_add_f32 v37, v37, v41
    v_add_f32 v36, v36, v42
    v_add_f32 v37, v37, v43
    v_add_f32 v36, v36, v44
    v_add_f32 v37, v37, v45
    v_add_f32 v36, v36, v46
    v_add_f32 v37, v37, v47
    v_add_f32 v36, v36, v48
    v_add_f32 v37, v37, v49
    v_add_f32 v36, v36, v50
    v_add_f32 v37, v37, v51
    v_cvt_pk_bf16_f32 v22, v36, v37
    ds_bpermute_b32 v12, v11, v22 offset:0
    ds_bpermute_b32 v13, v11, v22 offset:4
    ds_bpermute_b32 v14, v11, v22 offset:8
    ds_bpermute_b32 v15, v11, v22 offset:12
    s_waitcnt lgkmcnt(0)
    v_dot2_f32_bf16 v16, v156, v12, 0
    v_dot2_f32_bf16 v16, v157, v13, v16
    v_dot2_f32_bf16 v16, v158, v14, v16
    v_dot2_f32_bf16 v16, v159, v15, v16
    v_dot2_f32_bf16 v17, v160, v12, 0
    v_dot2_f32_bf16 v17, v161, v13, v17
    v_dot2_f32_bf16 v17, v162, v14, v17
    v_dot2_f32_bf16 v17, v163, v15, v17
    s_waitcnt vmcnt(9)
    v_dot2_f32_bf16 v18, v164, v12, 0
    v_dot2_f32_bf16 v18, v165, v13, v18
    v_dot2_f32_bf16 v18, v166, v14, v18
    v_dot2_f32_bf16 v18, v167, v15, v18
    s_waitcnt vmcnt(8)
    v_dot2_f32_bf16 v19, v168, v12, 0
    v_dot2_f32_bf16 v19, v169, v13, v19
    v_dot2_f32_bf16 v19, v170, v14, v19
    v_dot2_f32_bf16 v19, v171, v15, v19
    v_add_f32_dpp v20, v16, v16 row_ror:8 row_mask:0xf bank_mask:0x3
    v_add_f32_dpp v20, v17, v17 row_ror:8 row_mask:0xf bank_mask:0xc
    v_add_f32_dpp v21, v18, v18 row_ror:8 row_mask:0xf bank_mask:0x3
    v_add_f32_dpp v21, v19, v19 row_ror:8 row_mask:0xf bank_mask:0xc
    v_add_f32_dpp v36, v20, v20 row_shl:4 row_mask:0xf bank_mask:0x5
    s_nop 0
    v_add_f32_dpp v36, v21, v21 row_shr:4 row_mask:0xf bank_mask:0xa
    s_nop 1
    v_add_f32_dpp v36, v36, v36 quad_perm:[1,0,3,2] row_mask:0xf bank_mask:0xf
    s_nop 1
    v_add_f32_dpp v36, v36, v36 quad_perm:[2,3,0,1] row_mask:0xf bank_mask:0xf
    s_waitcnt vmcnt(7)
    v_dot2_f32_bf16 v16, v172, v12, 0
    v_dot2_f32_bf16 v16, v173, v13, v16
    v_dot2_f32_bf16 v16, v174, v14, v16
    v_dot2_f32_bf16 v16, v175, v15, v16
    s_waitcnt vmcnt(6)
    v_dot2_f32_bf16 v17, v176, v12, 0
    v_dot2_f32_bf16 v17, v177, v13, v17
    v_dot2_f32_bf16 v17, v178, v14, v17
    v_dot2_f32_bf16 v17, v179, v15, v17
    s_waitcnt vmcnt(5)
    v_dot2_f32_bf16 v18, v180, v12, 0
    v_dot2_f32_bf16 v18, v181, v13, v18
    v_dot2_f32_bf16 v18, v182, v14, v18
    v_dot2_f32_bf16 v18, v183, v15, v18
    s_add_u32 s71, s63, 98304
    buffer_load_dwordx4 v[156:159], v1, s[20:23], s71 offen offset:0 nt
    s_waitcnt vmcnt(5)
    v_dot2_f32_bf16 v19, v184, v12, 0
    v_dot2_f32_bf16 v19, v185, v13, v19
    v_dot2_f32_bf16 v19, v186, v14, v19
    v_dot2_f32_bf16 v19, v187, v15, v19
    buffer_load_dwordx4 v[160:163], v1, s[20:23], s71 offen offset:1024 nt
    v_add_f32_dpp v20, v16, v16 row_ror:8 row_mask:0xf bank_mask:0x3
    v_add_f32_dpp v20, v17, v17 row_ror:8 row_mask:0xf bank_mask:0xc
    v_add_f32_dpp v21, v18, v18 row_ror:8 row_mask:0xf bank_mask:0x3
    v_add_f32_dpp v21, v19, v19 row_ror:8 row_mask:0xf bank_mask:0xc
    v_add_f32_dpp v37, v20, v20 row_shl:4 row_mask:0xf bank_mask:0x5
    s_nop 0
    v_add_f32_dpp v37, v21, v21 row_shr:4 row_mask:0xf bank_mask:0xa
    s_nop 1
    v_add_f32_dpp v37, v37, v37 quad_perm:[1,0,3,2] row_mask:0xf bank_mask:0xf
    s_nop 1
    v_add_f32_dpp v37, v37, v37 quad_perm:[2,3,0,1] row_mask:0xf bank_mask:0xf
    s_waitcnt vmcnt(5)
    v_dot2_f32_bf16 v16, v188, v12, 0
    v_dot2_f32_bf16 v16, v189, v13, v16
    v_dot2_f32_bf16 v16, v190, v14, v16
    v_dot2_f32_bf16 v16, v191, v15, v16
    buffer_load_dwordx4 v[164:167], v1, s[20:23], s71 offen offset:2048 nt
    s_waitcnt vmcnt(5)
    v_dot2_f32_bf16 v17, v192, v12, 0
    v_dot2_f32_bf16 v17, v193, v13, v17
    v_dot2_f32_bf16 v17, v194, v14, v17
    v_dot2_f32_bf16 v17, v195, v15, v17
    buffer_load_dwordx4 v[168:171], v1, s[20:23], s71 offen offset:3072 nt
    s_waitcnt vmcnt(5)
    v_dot2_f32_bf16 v18, v196, v12, 0
    v_dot2_f32_bf16 v18, v197, v13, v18
    v_dot2_f32_bf16 v18, v198, v14, v18
    v_dot2_f32_bf16 v18, v199, v15, v18
    s_add_u32 s72, s63, 131072
    buffer_load_dwordx4 v[172:175], v1, s[20:23], s72 offen offset:0 nt
    s_waitcnt vmcnt(5)
    v_dot2_f32_bf16 v19, v200, v12, 0
    v_dot2_f32_bf16 v19, v201, v13, v19
    v_dot2_f32_bf16 v19, v202, v14, v19
    v_dot2_f32_bf16 v19, v203, v15, v19
    buffer_load_dwordx4 v[176:179], v1, s[20:23], s72 offen offset:1024 nt
    v_add_f32_dpp v20, v16, v16 row_ror:8 row_mask:0xf bank_mask:0x3
    v_add_f32_dpp v20, v17, v17 row_ror:8 row_mask:0xf bank_mask:0xc
    v_add_f32_dpp v21, v18, v18 row_ror:8 row_mask:0xf bank_mask:0x3
    v_add_f32_dpp v21, v19, v19 row_ror:8 row_mask:0xf bank_mask:0xc
    v_add_f32_dpp v38, v20, v20 row_shl:4 row_mask:0xf bank_mask:0x5
    s_nop 0
    v_add_f32_dpp v38, v21, v21 row_shr:4 row_mask:0xf bank_mask:0xa
    s_nop 1
    v_add_f32_dpp v38, v38, v38 quad_perm:[1,0,3,2] row_mask:0xf bank_mask:0xf
    s_nop 1
    v_add_f32_dpp v38, v38, v38 quad_perm:[2,3,0,1] row_mask:0xf bank_mask:0xf
    s_waitcnt vmcnt(5)
    v_dot2_f32_bf16 v16, v156, v12, 0
    v_dot2_f32_bf16 v16, v157, v13, v16
    v_dot2_f32_bf16 v16, v158, v14, v16
    v_dot2_f32_bf16 v16, v159, v15, v16
    buffer_load_dwordx4 v[180:183], v1, s[20:23], s72 offen offset:2048 nt
    s_waitcnt vmcnt(5)
    v_dot2_f32_bf16 v17, v160, v12, 0
    v_dot2_f32_bf16 v17, v161, v13, v17
    v_dot2_f32_bf16 v17, v162, v14, v17
    v_dot2_f32_bf16 v17, v163, v15, v17
    buffer_load_dwordx4 v[184:187], v1, s[20:23], s72 offen offset:3072 nt
    s_waitcnt vmcnt(5)
    v_dot2_f32_bf16 v18, v164, v12, 0
    v_dot2_f32_bf16 v18, v165, v13, v18
    v_dot2_f32_bf16 v18, v166, v14, v18
    v_dot2_f32_bf16 v18, v167, v15, v18
    s_add_u32 s73, s63, 163840
    buffer_load_dwordx4 v[188:191], v1, s[20:23], s73 offen offset:0 nt
    s_waitcnt vmcnt(5)
    v_dot2_f32_bf16 v19, v168, v12, 0
    v_dot2_f32_bf16 v19, v169, v13, v19
    v_dot2_f32_bf16 v19, v170, v14, v19
    v_dot2_f32_bf16 v19, v171, v15, v19
    buffer_load_dwordx4 v[192:195], v1, s[20:23], s73 offen offset:1024 nt
    v_add_f32_dpp v20, v16, v16 row_ror:8 row_mask:0xf bank_mask:0x3
    v_add_f32_dpp v20, v17, v17 row_ror:8 row_mask:0xf bank_mask:0xc
    v_add_f32_dpp v21, v18, v18 row_ror:8 row_mask:0xf bank_mask:0x3
    v_add_f32_dpp v21, v19, v19 row_ror:8 row_mask:0xf bank_mask:0xc
    v_add_f32_dpp v39, v20, v20 row_shl:4 row_mask:0xf bank_mask:0x5
    s_nop 0
    v_add_f32_dpp v39, v21, v21 row_shr:4 row_mask:0xf bank_mask:0xa
    s_nop 1
    v_add_f32_dpp v39, v39, v39 quad_perm:[1,0,3,2] row_mask:0xf bank_mask:0xf
    s_nop 1
    v_add_f32_dpp v39, v39, v39 quad_perm:[2,3,0,1] row_mask:0xf bank_mask:0xf
    s_waitcnt vmcnt(5)
    v_dot2_f32_bf16 v16, v172, v12, 0
    v_dot2_f32_bf16 v16, v173, v13, v16
    v_dot2_f32_bf16 v16, v174, v14, v16
    v_dot2_f32_bf16 v16, v175, v15, v16
    buffer_load_dwordx4 v[196:199], v1, s[20:23], s73 offen offset:2048 nt
    s_waitcnt vmcnt(5)
    v_dot2_f32_bf16 v17, v176, v12, 0
    v_dot2_f32_bf16 v17, v177, v13, v17
    v_dot2_f32_bf16 v17, v178, v14, v17
    v_dot2_f32_bf16 v17, v179, v15, v17
    buffer_load_dwordx4 v[200:203], v1, s[20:23], s73 offen offset:3072 nt
    s_waitcnt vmcnt(5)
    v_dot2_f32_bf16 v18, v180, v12, 0
    v_dot2_f32_bf16 v18, v181, v13, v18
    v_dot2_f32_bf16 v18, v182, v14, v18
    v_dot2_f32_bf16 v18, v183, v15, v18
    s_add_u32 s74, s63, 196608
    buffer_load_dwordx4 v[156:159], v1, s[20:23], s74 offen offset:0 nt
    s_waitcnt vmcnt(5)
    v_dot2_f32_bf16 v19, v184, v12, 0
    v_dot2_f32_bf16 v19, v185, v13, v19
    v_dot2_f32_bf16 v19, v186, v14, v19
    v_dot2_f32_bf16 v19, v187, v15, v19
    buffer_load_dwordx4 v[160:163], v1, s[20:23], s74 offen offset:1024 nt
    v_add_f32_dpp v20, v16, v16 row_ror:8 row_mask:0xf bank_mask:0x3
    v_add_f32_dpp v20, v17, v17 row_ror:8 row_mask:0xf bank_mask:0xc
    v_add_f32_dpp v21, v18, v18 row_ror:8 row_mask:0xf bank_mask:0x3
    v_add_f32_dpp v21, v19, v19 row_ror:8 row_mask:0xf bank_mask:0xc
    v_add_f32_dpp v40, v20, v20 row_shl:4 row_mask:0xf bank_mask:0x5
    s_nop 0
    v_add_f32_dpp v40, v21, v21 row_shr:4 row_mask:0xf bank_mask:0xa
    s_nop 1
    v_add_f32_dpp v40, v40, v40 quad_perm:[1,0,3,2] row_mask:0xf bank_mask:0xf
    s_nop 1
    v_add_f32_dpp v40, v40, v40 quad_perm:[2,3,0,1] row_mask:0xf bank_mask:0xf
    s_waitcnt vmcnt(5)
    v_dot2_f32_bf16 v16, v188, v12, 0
    v_dot2_f32_bf16 v16, v189, v13, v16
    v_dot2_f32_bf16 v16, v190, v14, v16
    v_dot2_f32_bf16 v16, v191, v15, v16
    buffer_load_dwordx4 v[164:167], v1, s[20:23], s74 offen offset:2048 nt
    s_waitcnt vmcnt(5)
    v_dot2_f32_bf16 v17, v192, v12, 0
    v_dot2_f32_bf16 v17, v193, v13, v17
    v_dot2_f32_bf16 v17, v194, v14, v17
    v_dot2_f32_bf16 v17, v195, v15, v17
    buffer_load_dwordx4 v[168:171], v1, s[20:23], s74 offen offset:3072 nt
    s_waitcnt vmcnt(5)
    v_dot2_f32_bf16 v18, v196, v12, 0
    v_dot2_f32_bf16 v18, v197, v13, v18
    v_dot2_f32_bf16 v18, v198, v14, v18
    v_dot2_f32_bf16 v18, v199, v15, v18
    s_add_u32 s75, s63, 229376
    buffer_load_dwordx4 v[172:175], v1, s[20:23], s75 offen offset:0 nt
    s_waitcnt vmcnt(5)
    v_dot2_f32_bf16 v19, v200, v12, 0
    v_dot2_f32_bf16 v19, v201, v13, v19
    v_dot2_f32_bf16 v19, v202, v14, v19
    v_dot2_f32_bf16 v19, v203, v15, v19
    buffer_load_dwordx4 v[176:179], v1, s[20:23], s75 offen offset:1024 nt
    v_add_f32_dpp v20, v16, v16 row_ror:8 row_mask:0xf bank_mask:0x3
    v_add_f32_dpp v20, v17, v17 row_ror:8 row_mask:0xf bank_mask:0xc
    v_add_f32_dpp v21, v18, v18 row_ror:8 row_mask:0xf bank_mask:0x3
    v_add_f32_dpp v21, v19, v19 row_ror:8 row_mask:0xf bank_mask:0xc
    v_add_f32_dpp v41, v20, v20 row_shl:4 row_mask:0xf bank_mask:0x5
    s_nop 0
    v_add_f32_dpp v41, v21, v21 row_shr:4 row_mask:0xf bank_mask:0xa
    s_nop 1
    v_add_f32_dpp v41, v41, v41 quad_perm:[1,0,3,2] row_mask:0xf bank_mask:0xf
    s_nop 1
    v_add_f32_dpp v41, v41, v41 quad_perm:[2,3,0,1] row_mask:0xf bank_mask:0xf
    s_waitcnt vmcnt(5)
    v_dot2_f32_bf16 v16, v156, v12, 0
    v_dot2_f32_bf16 v16, v157, v13, v16
    v_dot2_f32_bf16 v16, v158, v14, v16
    v_dot2_f32_bf16 v16, v159, v15, v16
    buffer_load_dwordx4 v[180:183], v1, s[20:23], s75 offen offset:2048 nt
    s_waitcnt vmcnt(5)
    v_dot2_f32_bf16 v17, v160, v12, 0
    v_dot2_f32_bf16 v17, v161, v13, v17
    v_dot2_f32_bf16 v17, v162, v14, v17
    v_dot2_f32_bf16 v17, v163, v15, v17
    buffer_load_dwordx4 v[184:187], v1, s[20:23], s75 offen offset:3072 nt
    s_waitcnt vmcnt(5)
    v_dot2_f32_bf16 v18, v164, v12, 0
    v_dot2_f32_bf16 v18, v165, v13, v18
    v_dot2_f32_bf16 v18, v166, v14, v18
    v_dot2_f32_bf16 v18, v167, v15, v18
    s_add_u32 s76, s63, 262144
    buffer_load_dwordx4 v[188:191], v1, s[20:23], s76 offen offset:0 nt
    s_waitcnt vmcnt(5)
    v_dot2_f32_bf16 v19, v168, v12, 0
    v_dot2_f32_bf16 v19, v169, v13, v19
    v_dot2_f32_bf16 v19, v170, v14, v19
    v_dot2_f32_bf16 v19, v171, v15, v19
    buffer_load_dwordx4 v[192:195], v1, s[20:23], s76 offen offset:1024 nt
    v_add_f32_dpp v20, v16, v16 row_ror:8 row_mask:0xf bank_mask:0x3
    v_add_f32_dpp v20, v17, v17 row_ror:8 row_mask:0xf bank_mask:0xc
    v_add_f32_dpp v21, v18, v18 row_ror:8 row_mask:0xf bank_mask:0x3
    v_add_f32_dpp v21, v19, v19 row_ror:8 row_mask:0xf bank_mask:0xc
    v_add_f32_dpp v42, v20, v20 row_shl:4 row_mask:0xf bank_mask:0x5
    s_nop 0
    v_add_f32_dpp v42, v21, v21 row_shr:4 row_mask:0xf bank_mask:0xa
    s_nop 1
    v_add_f32_dpp v42, v42, v42 quad_perm:[1,0,3,2] row_mask:0xf bank_mask:0xf
    s_nop 1
    v_add_f32_dpp v42, v42, v42 quad_perm:[2,3,0,1] row_mask:0xf bank_mask:0xf
    s_waitcnt vmcnt(5)
    v_dot2_f32_bf16 v16, v172, v12, 0
    v_dot2_f32_bf16 v16, v173, v13, v16
    v_dot2_f32_bf16 v16, v174, v14, v16
    v_dot2_f32_bf16 v16, v175, v15, v16
    buffer_load_dwordx4 v[196:199], v1, s[20:23], s76 offen offset:2048 nt
    s_waitcnt vmcnt(5)
    v_dot2_f32_bf16 v17, v176, v12, 0
    v_dot2_f32_bf16 v17, v177, v13, v17
    v_dot2_f32_bf16 v17, v178, v14, v17
    v_dot2_f32_bf16 v17, v179, v15, v17
    buffer_load_dwordx4 v[200:203], v1, s[20:23], s76 offen offset:3072 nt
    s_waitcnt vmcnt(5)
    v_dot2_f32_bf16 v18, v180, v12, 0
    v_dot2_f32_bf16 v18, v181, v13, v18
    v_dot2_f32_bf16 v18, v182, v14, v18
    v_dot2_f32_bf16 v18, v183, v15, v18
    s_add_u32 s77, s63, 294912
    buffer_load_dwordx4 v[156:159], v1, s[20:23], s77 offen offset:0 nt
    s_waitcnt vmcnt(5)
    v_dot2_f32_bf16 v19, v184, v12, 0
    v_dot2_f32_bf16 v19, v185, v13, v19
    v_dot2_f32_bf16 v19, v186, v14, v19
    v_dot2_f32_bf16 v19, v187, v15, v19
    buffer_load_dwordx4 v[160:163], v1, s[20:23], s77 offen offset:1024 nt
    v_add_f32_dpp v20, v16, v16 row_ror:8 row_mask:0xf bank_mask:0x3
    v_add_f32_dpp v20, v17, v17 row_ror:8 row_mask:0xf bank_mask:0xc
    v_add_f32_dpp v21, v18, v18 row_ror:8 row_mask:0xf bank_mask:0x3
    v_add_f32_dpp v21, v19, v19 row_ror:8 row_mask:0xf bank_mask:0xc
    v_add_f32_dpp v43, v20, v20 row_shl:4 row_mask:0xf bank_mask:0x5
    s_nop 0
    v_add_f32_dpp v43, v21, v21 row_shr:4 row_mask:0xf bank_mask:0xa
    s_nop 1
    v_add_f32_dpp v43, v43, v43 quad_perm:[1,0,3,2] row_mask:0xf bank_mask:0xf
    s_nop 1
    v_add_f32_dpp v43, v43, v43 quad_perm:[2,3,0,1] row_mask:0xf bank_mask:0xf
    s_waitcnt vmcnt(5)
    v_dot2_f32_bf16 v16, v188, v12, 0
    v_dot2_f32_bf16 v16, v189, v13, v16
    v_dot2_f32_bf16 v16, v190, v14, v16
    v_dot2_f32_bf16 v16, v191, v15, v16
    buffer_load_dwordx4 v[164:167], v1, s[20:23], s77 offen offset:2048 nt
    s_waitcnt vmcnt(5)
    v_dot2_f32_bf16 v17, v192, v12, 0
    v_dot2_f32_bf16 v17, v193, v13, v17
    v_dot2_f32_bf16 v17, v194, v14, v17
    v_dot2_f32_bf16 v17, v195, v15, v17
    buffer_load_dwordx4 v[168:171], v1, s[20:23], s77 offen offset:3072 nt
    s_waitcnt vmcnt(5)
    v_dot2_f32_bf16 v18, v196, v12, 0
    v_dot2_f32_bf16 v18, v197, v13, v18
    v_dot2_f32_bf16 v18, v198, v14, v18
    v_dot2_f32_bf16 v18, v199, v15, v18
    s_add_u32 s78, s63, 327680
    buffer_load_dwordx4 v[172:175], v1, s[20:23], s78 offen offset:0 nt
    s_waitcnt vmcnt(5)
    v_dot2_f32_bf16 v19, v200, v12, 0
    v_dot2_f32_bf16 v19, v201, v13, v19
    v_dot2_f32_bf16 v19, v202, v14, v19
    v_dot2_f32_bf16 v19, v203, v15, v19
    buffer_load_dwordx4 v[176:179], v1, s[20:23], s78 offen offset:1024 nt
    v_add_f32_dpp v20, v16, v16 row_ror:8 row_mask:0xf bank_mask:0x3
    v_add_f32_dpp v20, v17, v17 row_ror:8 row_mask:0xf bank_mask:0xc
    v_add_f32_dpp v21, v18, v18 row_ror:8 row_mask:0xf bank_mask:0x3
    v_add_f32_dpp v21, v19, v19 row_ror:8 row_mask:0xf bank_mask:0xc
    v_add_f32_dpp v44, v20, v20 row_shl:4 row_mask:0xf bank_mask:0x5
    s_nop 0
    v_add_f32_dpp v44, v21, v21 row_shr:4 row_mask:0xf bank_mask:0xa
    s_nop 1
    v_add_f32_dpp v44, v44, v44 quad_perm:[1,0,3,2] row_mask:0xf bank_mask:0xf
    s_nop 1
    v_add_f32_dpp v44, v44, v44 quad_perm:[2,3,0,1] row_mask:0xf bank_mask:0xf
    s_waitcnt vmcnt(5)
    v_dot2_f32_bf16 v16, v156, v12, 0
    v_dot2_f32_bf16 v16, v157, v13, v16
    v_dot2_f32_bf16 v16, v158, v14, v16
    v_dot2_f32_bf16 v16, v159, v15, v16
    buffer_load_dwordx4 v[180:183], v1, s[20:23], s78 offen offset:2048 nt
    s_waitcnt vmcnt(5)
    v_dot2_f32_bf16 v17, v160, v12, 0
    v_dot2_f32_bf16 v17, v161, v13, v17
    v_dot2_f32_bf16 v17, v162, v14, v17
    v_dot2_f32_bf16 v17, v163, v15, v17
    buffer_load_dwordx4 v[184:187], v1, s[20:23], s78 offen offset:3072 nt
    s_waitcnt vmcnt(5)
    v_dot2_f32_bf16 v18, v164, v12, 0
    v_dot2_f32_bf16 v18, v165, v13, v18
    v_dot2_f32_bf16 v18, v166, v14, v18
    v_dot2_f32_bf16 v18, v167, v15, v18
    s_add_u32 s79, s63, 360448
    buffer_load_dwordx4 v[188:191], v1, s[20:23], s79 offen offset:0 nt
    s_waitcnt vmcnt(5)
    v_dot2_f32_bf16 v19, v168, v12, 0
    v_dot2_f32_bf16 v19, v169, v13, v19
    v_dot2_f32_bf16 v19, v170, v14, v19
    v_dot2_f32_bf16 v19, v171, v15, v19
    buffer_load_dwordx4 v[192:195], v1, s[20:23], s79 offen offset:1024 nt
    v_add_f32_dpp v20, v16, v16 row_ror:8 row_mask:0xf bank_mask:0x3
    v_add_f32_dpp v20, v17, v17 row_ror:8 row_mask:0xf bank_mask:0xc
    v_add_f32_dpp v21, v18, v18 row_ror:8 row_mask:0xf bank_mask:0x3
    v_add_f32_dpp v21, v19, v19 row_ror:8 row_mask:0xf bank_mask:0xc
    v_add_f32_dpp v45, v20, v20 row_shl:4 row_mask:0xf bank_mask:0x5
    s_nop 0
    v_add_f32_dpp v45, v21, v21 row_shr:4 row_mask:0xf bank_mask:0xa
    s_nop 1
    v_add_f32_dpp v45, v45, v45 quad_perm:[1,0,3,2] row_mask:0xf bank_mask:0xf
    s_nop 1
    v_add_f32_dpp v45, v45, v45 quad_perm:[2,3,0,1] row_mask:0xf bank_mask:0xf
    s_waitcnt vmcnt(5)
    v_dot2_f32_bf16 v16, v172, v12, 0
    v_dot2_f32_bf16 v16, v173, v13, v16
    v_dot2_f32_bf16 v16, v174, v14, v16
    v_dot2_f32_bf16 v16, v175, v15, v16
    buffer_load_dwordx4 v[196:199], v1, s[20:23], s79 offen offset:2048 nt
    s_waitcnt vmcnt(5)
    v_dot2_f32_bf16 v17, v176, v12, 0
    v_dot2_f32_bf16 v17, v177, v13, v17
    v_dot2_f32_bf16 v17, v178, v14, v17
    v_dot2_f32_bf16 v17, v179, v15, v17
    buffer_load_dwordx4 v[200:203], v1, s[20:23], s79 offen offset:3072 nt
    s_waitcnt vmcnt(5)
    v_dot2_f32_bf16 v18, v180, v12, 0
    v_dot2_f32_bf16 v18, v181, v13, v18
    v_dot2_f32_bf16 v18, v182, v14, v18
    v_dot2_f32_bf16 v18, v183, v15, v18
    s_add_u32 s80, s63, 393216
    buffer_load_dwordx4 v[156:159], v1, s[20:23], s80 offen offset:0 nt
    s_waitcnt vmcnt(5)
    v_dot2_f32_bf16 v19, v184, v12, 0
    v_dot2_f32_bf16 v19, v185, v13, v19
    v_dot2_f32_bf16 v19, v186, v14, v19
    v_dot2_f32_bf16 v19, v187, v15, v19
    buffer_load_dwordx4 v[160:163], v1, s[20:23], s80 offen offset:1024 nt
    v_add_f32_dpp v20, v16, v16 row_ror:8 row_mask:0xf bank_mask:0x3
    v_add_f32_dpp v20, v17, v17 row_ror:8 row_mask:0xf bank_mask:0xc
    v_add_f32_dpp v21, v18, v18 row_ror:8 row_mask:0xf bank_mask:0x3
    v_add_f32_dpp v21, v19, v19 row_ror:8 row_mask:0xf bank_mask:0xc
    v_add_f32_dpp v46, v20, v20 row_shl:4 row_mask:0xf bank_mask:0x5
    s_nop 0
    v_add_f32_dpp v46, v21, v21 row_shr:4 row_mask:0xf bank_mask:0xa
    s_nop 1
    v_add_f32_dpp v46, v46, v46 quad_perm:[1,0,3,2] row_mask:0xf bank_mask:0xf
    s_nop 1
    v_add_f32_dpp v46, v46, v46 quad_perm:[2,3,0,1] row_mask:0xf bank_mask:0xf
    s_waitcnt vmcnt(5)
    v_dot2_f32_bf16 v16, v188, v12, 0
    v_dot2_f32_bf16 v16, v189, v13, v16
    v_dot2_f32_bf16 v16, v190, v14, v16
    v_dot2_f32_bf16 v16, v191, v15, v16
    buffer_load_dwordx4 v[164:167], v1, s[20:23], s80 offen offset:2048 nt
    s_waitcnt vmcnt(5)
    v_dot2_f32_bf16 v17, v192, v12, 0
    v_dot2_f32_bf16 v17, v193, v13, v17
    v_dot2_f32_bf16 v17, v194, v14, v17
    v_dot2_f32_bf16 v17, v195, v15, v17
    buffer_load_dwordx4 v[168:171], v1, s[20:23], s80 offen offset:3072 nt
    s_waitcnt vmcnt(5)
    v_dot2_f32_bf16 v18, v196, v12, 0
    v_dot2_f32_bf16 v18, v197, v13, v18
    v_dot2_f32_bf16 v18, v198, v14, v18
    v_dot2_f32_bf16 v18, v199, v15, v18
    s_add_u32 s81, s63, 425984
    buffer_load_dwordx4 v[172:175], v1, s[20:23], s81 offen offset:0 nt
    s_waitcnt vmcnt(5)
    v_dot2_f32_bf16 v19, v200, v12, 0
    v_dot2_f32_bf16 v19, v201, v13, v19
    v_dot2_f32_bf16 v19, v202, v14, v19
    v_dot2_f32_bf16 v19, v203, v15, v19
    buffer_load_dwordx4 v[176:179], v1, s[20:23], s81 offen offset:1024 nt
    v_add_f32_dpp v20, v16, v16 row_ror:8 row_mask:0xf bank_mask:0x3
    v_add_f32_dpp v20, v17, v17 row_ror:8 row_mask:0xf bank_mask:0xc
    v_add_f32_dpp v21, v18, v18 row_ror:8 row_mask:0xf bank_mask:0x3
    v_add_f32_dpp v21, v19, v19 row_ror:8 row_mask:0xf bank_mask:0xc
    v_add_f32_dpp v47, v20, v20 row_shl:4 row_mask:0xf bank_mask:0x5
    s_nop 0
    v_add_f32_dpp v47, v21, v21 row_shr:4 row_mask:0xf bank_mask:0xa
    s_nop 1
    v_add_f32_dpp v47, v47, v47 quad_perm:[1,0,3,2] row_mask:0xf bank_mask:0xf
    s_nop 1
    v_add_f32_dpp v47, v47, v47 quad_perm:[2,3,0,1] row_mask:0xf bank_mask:0xf
    s_waitcnt vmcnt(5)
    v_dot2_f32_bf16 v16, v156, v12, 0
    v_dot2_f32_bf16 v16, v157, v13, v16
    v_dot2_f32_bf16 v16, v158, v14, v16
    v_dot2_f32_bf16 v16, v159, v15, v16
    buffer_load_dwordx4 v[180:183], v1, s[20:23], s81 offen offset:2048 nt
    s_waitcnt vmcnt(5)
    v_dot2_f32_bf16 v17, v160, v12, 0
    v_dot2_f32_bf16 v17, v161, v13, v17
    v_dot2_f32_bf16 v17, v162, v14, v17
    v_dot2_f32_bf16 v17, v163, v15, v17
    buffer_load_dwordx4 v[184:187], v1, s[20:23], s81 offen offset:3072 nt
    s_waitcnt vmcnt(5)
    v_dot2_f32_bf16 v18, v164, v12, 0
    v_dot2_f32_bf16 v18, v165, v13, v18
    v_dot2_f32_bf16 v18, v166, v14, v18
    v_dot2_f32_bf16 v18, v167, v15, v18
    s_add_u32 s82, s63, 458752
    buffer_load_dwordx4 v[188:191], v1, s[20:23], s82 offen offset:0 nt
    s_waitcnt vmcnt(5)
    v_dot2_f32_bf16 v19, v168, v12, 0
    v_dot2_f32_bf16 v19, v169, v13, v19
    v_dot2_f32_bf16 v19, v170, v14, v19
    v_dot2_f32_bf16 v19, v171, v15, v19
    buffer_load_dwordx4 v[192:195], v1, s[20:23], s82 offen offset:1024 nt
    v_add_f32_dpp v20, v16, v16 row_ror:8 row_mask:0xf bank_mask:0x3
    v_add_f32_dpp v20, v17, v17 row_ror:8 row_mask:0xf bank_mask:0xc
    v_add_f32_dpp v21, v18, v18 row_ror:8 row_mask:0xf bank_mask:0x3
    v_add_f32_dpp v21, v19, v19 row_ror:8 row_mask:0xf bank_mask:0xc
    v_add_f32_dpp v48, v20, v20 row_shl:4 row_mask:0xf bank_mask:0x5
    s_nop 0
    v_add_f32_dpp v48, v21, v21 row_shr:4 row_mask:0xf bank_mask:0xa
    s_nop 1
    v_add_f32_dpp v48, v48, v48 quad_perm:[1,0,3,2] row_mask:0xf bank_mask:0xf
    s_nop 1
    v_add_f32_dpp v48, v48, v48 quad_perm:[2,3,0,1] row_mask:0xf bank_mask:0xf
    s_waitcnt vmcnt(5)
    v_dot2_f32_bf16 v16, v172, v12, 0
    v_dot2_f32_bf16 v16, v173, v13, v16
    v_dot2_f32_bf16 v16, v174, v14, v16
    v_dot2_f32_bf16 v16, v175, v15, v16
    buffer_load_dwordx4 v[196:199], v1, s[20:23], s82 offen offset:2048 nt
    s_waitcnt vmcnt(5)
    v_dot2_f32_bf16 v17, v176, v12, 0
    v_dot2_f32_bf16 v17, v177, v13, v17
    v_dot2_f32_bf16 v17, v178, v14, v17
    v_dot2_f32_bf16 v17, v179, v15, v17
    buffer_load_dwordx4 v[200:203], v1, s[20:23], s82 offen offset:3072 nt
    s_waitcnt vmcnt(5)
    v_dot2_f32_bf16 v18, v180, v12, 0
    v_dot2_f32_bf16 v18, v181, v13, v18
    v_dot2_f32_bf16 v18, v182, v14, v18
    v_dot2_f32_bf16 v18, v183, v15, v18
    s_add_u32 s83, s63, 491520
    buffer_load_dwordx4 v[156:159], v1, s[20:23], s83 offen offset:0 nt
    s_waitcnt vmcnt(5)
    v_dot2_f32_bf16 v19, v184, v12, 0
    v_dot2_f32_bf16 v19, v185, v13, v19
    v_dot2_f32_bf16 v19, v186, v14, v19
    v_dot2_f32_bf16 v19, v187, v15, v19
    buffer_load_dwordx4 v[160:163], v1, s[20:23], s83 offen offset:1024 nt
    v_add_f32_dpp v20, v16, v16 row_ror:8 row_mask:0xf bank_mask:0x3
    v_add_f32_dpp v20, v17, v17 row_ror:8 row_mask:0xf bank_mask:0xc
    v_add_f32_dpp v21, v18, v18 row_ror:8 row_mask:0xf bank_mask:0x3
    v_add_f32_dpp v21, v19, v19 row_ror:8 row_mask:0xf bank_mask:0xc
    v_add_f32_dpp v49, v20, v20 row_shl:4 row_mask:0xf bank_mask:0x5
    s_nop 0
    v_add_f32_dpp v49, v21, v21 row_shr:4 row_mask:0xf bank_mask:0xa
    s_nop 1
    v_add_f32_dpp v49, v49, v49 quad_perm:[1,0,3,2] row_mask:0xf bank_mask:0xf
    s_nop 1
    v_add_f32_dpp v49, v49, v49 quad_perm:[2,3,0,1] row_mask:0xf bank_mask:0xf
    s_waitcnt vmcnt(5)
    v_dot2_f32_bf16 v16, v188, v12, 0
    v_dot2_f32_bf16 v16, v189, v13, v16
    v_dot2_f32_bf16 v16, v190, v14, v16
    v_dot2_f32_bf16 v16, v191, v15, v16
    buffer_load_dwordx4 v[164:167], v1, s[20:23], s83 offen offset:2048 nt
    s_waitcnt vmcnt(5)
    v_dot2_f32_bf16 v17, v192, v12, 0
    v_dot2_f32_bf16 v17, v193, v13, v17
    v_dot2_f32_bf16 v17, v194, v14, v17
    v_dot2_f32_bf16 v17, v195, v15, v17
    buffer_load_dwordx4 v[168:171], v1, s[20:23], s83 offen offset:3072 nt
    s_waitcnt vmcnt(5)
    v_dot2_f32_bf16 v18, v196, v12, 0
    v_dot2_f32_bf16 v18, v197, v13, v18
    v_dot2_f32_bf16 v18, v198, v14, v18
    v_dot2_f32_bf16 v18, v199, v15, v18
    buffer_load_dwordx4 v[172:175], v1, s[24:27], s68 offen offset:0 nt
    s_waitcnt vmcnt(5)
    v_dot2_f32_bf16 v19, v200, v12, 0
    v_dot2_f32_bf16 v19, v201, v13, v19
    v_dot2_f32_bf16 v19, v202, v14, v19
    v_dot2_f32_bf16 v19, v203, v15, v19
    buffer_load_dwordx4 v[176:179], v1, s[24:27], s68 offen offset:1024 nt
    v_add_f32_dpp v20, v16, v16 row_ror:8 row_mask:0xf bank_mask:0x3
    v_add_f32_dpp v20, v17, v17 row_ror:8 row_mask:0xf bank_mask:0xc
    v_add_f32_dpp v21, v18, v18 row_ror:8 row_mask:0xf bank_mask:0x3
    v_add_f32_dpp v21, v19, v19 row_ror:8 row_mask:0xf bank_mask:0xc
    v_add_f32_dpp v50, v20, v20 row_shl:4 row_mask:0xf bank_mask:0x5
    s_nop 0
    v_add_f32_dpp v50, v21, v21 row_shr:4 row_mask:0xf bank_mask:0xa
    s_nop 1
    v_add_f32_dpp v50, v50, v50 quad_perm:[1,0,3,2] row_mask:0xf bank_mask:0xf
    s_nop 1
    v_add_f32_dpp v50, v50, v50 quad_perm:[2,3,0,1] row_mask:0xf bank_mask:0xf
    s_waitcnt vmcnt(5)
    v_dot2_f32_bf16 v16, v156, v12, 0
    v_dot2_f32_bf16 v16, v157, v13, v16
    v_dot2_f32_bf16 v16, v158, v14, v16
    v_dot2_f32_bf16 v16, v159, v15, v16
    buffer_load_dwordx4 v[180:183], v1, s[24:27], s68 offen offset:2048 nt
    s_waitcnt vmcnt(5)
    v_dot2_f32_bf16 v17, v160, v12, 0
    v_dot2_f32_bf16 v17, v161, v13, v17
    v_dot2_f32_bf16 v17, v162, v14, v17
    v_dot2_f32_bf16 v17, v163, v15, v17
    buffer_load_dwordx4 v[184:187], v1, s[24:27], s68 offen offset:3072 nt
    s_waitcnt vmcnt(5)
    v_dot2_f32_bf16 v18, v164, v12, 0
    v_dot2_f32_bf16 v18, v165, v13, v18
    v_dot2_f32_bf16 v18, v166, v14, v18
    v_dot2_f32_bf16 v18, v167, v15, v18
    buffer_load_dwordx4 v[188:191], v1, s[24:27], s69 offen offset:0 nt
    s_waitcnt vmcnt(5)
    v_dot2_f32_bf16 v19, v168, v12, 0
    v_dot2_f32_bf16 v19, v169, v13, v19
    v_dot2_f32_bf16 v19, v170, v14, v19
    v_dot2_f32_bf16 v19, v171, v15, v19
    buffer_load_dwordx4 v[192:195], v1, s[24:27], s69 offen offset:1024 nt
    buffer_load_dwordx4 v[76:79], v3, s[32:35], s57 offen offset:0
    v_add_f32_dpp v20, v16, v16 row_ror:8 row_mask:0xf bank_mask:0x3
    v_add_f32_dpp v20, v17, v17 row_ror:8 row_mask:0xf bank_mask:0xc
    v_add_f32_dpp v21, v18, v18 row_ror:8 row_mask:0xf bank_mask:0x3
    v_add_f32_dpp v21, v19, v19 row_ror:8 row_mask:0xf bank_mask:0xc
    v_add_f32_dpp v51, v20, v20 row_shl:4 row_mask:0xf bank_mask:0x5
    s_nop 0
    v_add_f32_dpp v51, v21, v21 row_shr:4 row_mask:0xf bank_mask:0xa
    s_nop 1
    v_add_f32_dpp v51, v51, v51 quad_perm:[1,0,3,2] row_mask:0xf bank_mask:0xf
    s_nop 1
    v_add_f32_dpp v51, v51, v51 quad_perm:[2,3,0,1] row_mask:0xf bank_mask:0xf
    v_max_f32 v16, v36, v37
    v_max3_f32 v16, v16, v38, v39
    v_max3_f32 v16, v16, v40, v41
    v_max3_f32 v16, v16, v42, v43
    v_max3_f32 v16, v16, v44, v45
    v_max3_f32 v16, v16, v46, v47
    v_max3_f32 v16, v16, v48, v49
    v_max3_f32 v16, v16, v50, v51
    s_nop 1
    v_max_f32_dpp v16, v16, v16 row_ror:4 row_mask:0xf bank_mask:0xf
    s_nop 1
    v_max_f32_dpp v16, v16, v16 row_ror:8 row_mask:0xf bank_mask:0xf
    s_nop 1
    v_max_f32_dpp v16, v16, v16 row_bcast:15 row_mask:0xa bank_mask:0xf
    s_nop 1
    v_max_f32_dpp v16, v16, v16 row_bcast:31 row_mask:0xc bank_mask:0xf
    s_nop 0
    v_readlane_b32 s59, v16, 63
    v_mov_b32 v17, s58
    s_nop 0
    v_mul_f32 v17, s59, v17
    v_fma_f32 v36, v36, s58, -v17
    v_fma_f32 v37, v37, s58, -v17
    v_fma_f32 v38, v38, s58, -v17
    v_fma_f32 v39, v39, s58, -v17
    v_fma_f32 v40, v40, s58, -v17
    v_fma_f32 v41, v41, s58, -v17
    v_fma_f32 v42, v42, s58, -v17
    v_fma_f32 v43, v43, s58, -v17
    v_fma_f32 v44, v44, s58, -v17
    v_fma_f32 v45, v45, s58, -v17
    v_fma_f32 v46, v46, s58, -v17
    v_fma_f32 v47, v47, s58, -v17
    v_fma_f32 v48, v48, s58, -v17
    v_fma_f32 v49, v49, s58, -v17
    v_fma_f32 v50, v50, s58, -v17
    v_fma_f32 v51, v51, s58, -v17
    v_exp_f32 v36, v36
    v_exp_f32 v37, v37
    v_exp_f32 v38, v38
    v_exp_f32 v39, v39
    v_exp_f32 v40, v40
    v_exp_f32 v41, v41
    v_exp_f32 v42, v42
    v_exp_f32 v43, v43
    v_exp_f32 v44, v44
    v_exp_f32 v45, v45
    v_exp_f32 v46, v46
    v_exp_f32 v47, v47
    v_exp_f32 v48, v48
    v_exp_f32 v49, v49
    v_exp_f32 v50, v50
    v_exp_f32 v51, v51
    v_add_f32 v18, v36, v37
    v_add_f32 v18, v18, v38
    v_add_f32 v18, v18, v39
    v_add_f32 v18, v18, v40
    v_add_f32 v18, v18, v41
    v_add_f32 v18, v18, v42
    v_add_f32 v18, v18, v43
    v_add_f32 v18, v18, v44
    v_add_f32 v18, v18, v45
    v_add_f32 v18, v18, v46
    v_add_f32 v18, v18, v47
    v_add_f32 v18, v18, v48
    v_add_f32 v18, v18, v49
    v_add_f32 v18, v18, v50
    v_add_f32 v18, v18, v51
    s_nop 1
    v_add_f32_dpp v18, v18, v18 row_ror:4 row_mask:0xf bank_mask:0xf
    s_nop 1
    v_add_f32_dpp v18, v18, v18 row_ror:8 row_mask:0xf bank_mask:0xf
    s_nop 1
    v_add_f32_dpp v18, v18, v18 row_bcast:15 row_mask:0xa bank_mask:0xf
    s_nop 1
    v_add_f32_dpp v18, v18, v18 row_bcast:31 row_mask:0xc bank_mask:0xf
    s_lshl_b32 s54, s48, 3
    v_mov_b32 v22, s54
    s_mov_b32 exec_lo, 0
    s_mov_b32 exec_hi, 0x80000000
    ds_write_b32 v22, v17 offset:8192
    ds_write_b32 v22, v18 offset:8196
    s_mov_b64 exec, -1
    v_mov_b32 v23, 0
    s_waitcnt lgkmcnt(0)
    s_barrier
    ds_read_b128 v[52:55], v23 offset:8192
    ds_read_b128 v[56:59], v23 offset:8208
    ds_read_b128 v[60:63], v23 offset:8224
    ds_read_b128 v[64:67], v23 offset:8240
    s_waitcnt lgkmcnt(0)
    v_max_f32 v16, v52, v54
    v_max3_f32 v16, v16, v56, v58
    v_max3_f32 v16, v16, v60, v62
    v_max3_f32 v16, v16, v64, v66
    v_sub_f32 v52, v52, v16
    v_sub_f32 v54, v54, v16
    v_sub_f32 v56, v56, v16
    v_sub_f32 v58, v58, v16
    v_sub_f32 v60, v60, v16
    v_sub_f32 v62, v62, v16
    v_sub_f32 v64, v64, v16
    v_sub_f32 v66, v66, v16
    v_sub_f32 v17, v17, v16
    v_exp_f32 v52, v52
    v_exp_f32 v54, v54
    v_exp_f32 v56, v56
    v_exp_f32 v58, v58
    v_exp_f32 v60, v60
    v_exp_f32 v62, v62
    v_exp_f32 v64, v64
    v_exp_f32 v66, v66
    v_exp_f32 v17, v17
    v_mul_f32 v18, v52, v53
    v_fmac_f32 v18, v54, v55
    v_fmac_f32 v18, v56, v57
    v_fmac_f32 v18, v58, v59
    v_fmac_f32 v18, v60, v61
    v_fmac_f32 v18, v62, v63
    v_fmac_f32 v18, v64, v65
    v_fmac_f32 v18, v66, v67
    v_rcp_f32 v18, v18
    s_nop 0
    v_mul_f32 v18, v18, v17
    v_mul_f32 v36, v36, v18
    v_mul_f32 v37, v37, v18
    v_mul_f32 v38, v38, v18
    v_mul_f32 v39, v39, v18
    v_mul_f32 v40, v40, v18
    v_mul_f32 v41, v41, v18
    v_mul_f32 v42, v42, v18
    v_mul_f32 v43, v43, v18
    v_mul_f32 v44, v44, v18
    v_mul_f32 v45, v45, v18
    v_mul_f32 v46, v46, v18
    v_mul_f32 v47, v47, v18
    v_mul_f32 v48, v48, v18
    v_mul_f32 v49, v49, v18
    v_mul_f32 v50, v50, v18
    v_mul_f32 v51, v51, v18
    v_cvt_pk_bf16_f32 v36, v36, v36
    v_cvt_pk_bf16_f32 v37, v37, v37
    v_cvt_pk_bf16_f32 v38, v38, v38
    v_cvt_pk_bf16_f32 v39, v39, v39
    v_cvt_pk_bf16_f32 v40, v40, v40
    v_cvt_pk_bf16_f32 v41, v41, v41
    v_cvt_pk_bf16_f32 v42, v42, v42
    v_cvt_pk_bf16_f32 v43, v43, v43
    v_cvt_pk_bf16_f32 v44, v44, v44
    v_cvt_pk_bf16_f32 v45, v45, v45
    v_cvt_pk_bf16_f32 v46, v46, v46
    v_cvt_pk_bf16_f32 v47, v47, v47
    v_cvt_pk_bf16_f32 v48, v48, v48
    v_cvt_pk_bf16_f32 v49, v49, v49
    v_cvt_pk_bf16_f32 v50, v50, v50
    v_cvt_pk_bf16_f32 v51, v51, v51
    v_and_b32_dpp v24, v36, v4 row_newbcast:0 row_mask:0xf bank_mask:0xf
    v_and_b32_dpp v25, v36, v5 row_newbcast:0 row_mask:0xf bank_mask:0xf
    v_and_b32_dpp v26, v36, v6 row_newbcast:0 row_mask:0xf bank_mask:0xf
    v_and_b32_dpp v27, v36, v7 row_newbcast:0 row_mask:0xf bank_mask:0xf
    s_waitcnt vmcnt(6)
    s_nop 0
    v_mfma_f32_16x16x32_bf16 v[32:35], v[172:175], v[24:27], 0
    buffer_load_dwordx4 v[196:199], v1, s[24:27], s69 offen offset:2048 nt
    buffer_load_dwordx4 v[80:83], v3, s[32:35], s57 offen offset:256
    v_and_b32_dpp v28, v36, v4 row_newbcast:8 row_mask:0xf bank_mask:0xf
    v_and_b32_dpp v29, v36, v5 row_newbcast:8 row_mask:0xf bank_mask:0xf
    v_and_b32_dpp v30, v36, v6 row_newbcast:8 row_mask:0xf bank_mask:0xf
    v_and_b32_dpp v31, v36, v7 row_newbcast:8 row_mask:0xf bank_mask:0xf
    s_waitcnt vmcnt(7)
    s_nop 0
    v_mfma_f32_16x16x32_bf16 v[32:35], v[176:179], v[28:31], v[32:35]
    buffer_load_dwordx4 v[200:203], v1, s[24:27], s69 offen offset:3072 nt
    buffer_load_dwordx4 v[84:87], v3, s[32:35], s57 offen offset:512
    v_and_b32_dpp v24, v36, v4 row_newbcast:4 row_mask:0xf bank_mask:0xf
    v_and_b32_dpp v25, v36, v5 row_newbcast:4 row_mask:0xf bank_mask:0xf
    v_and_b32_dpp v26, v36, v6 row_newbcast:4 row_mask:0xf bank_mask:0xf
    v_and_b32_dpp v27, v36, v7 row_newbcast:4 row_mask:0xf bank_mask:0xf
    s_waitcnt vmcnt(8)
    s_nop 0
    v_mfma_f32_16x16x32_bf16 v[32:35], v[180:183], v[24:27], v[32:35]
    buffer_load_dwordx4 v[156:159], v1, s[24:27], s70 offen offset:0 nt
    buffer_load_dwordx4 v[88:91], v3, s[32:35], s57 offen offset:768
    v_and_b32_dpp v28, v36, v4 row_newbcast:12 row_mask:0xf bank_mask:0xf
    v_and_b32_dpp v29, v36, v5 row_newbcast:12 row_mask:0xf bank_mask:0xf
    v_and_b32_dpp v30, v36, v6 row_newbcast:12 row_mask:0xf bank_mask:0xf
    v_and_b32_dpp v31, v36, v7 row_newbcast:12 row_mask:0xf bank_mask:0xf
    s_waitcnt vmcnt(9)
    s_nop 0
    v_mfma_f32_16x16x32_bf16 v[32:35], v[184:187], v[28:31], v[32:35]
    buffer_load_dwordx4 v[160:163], v1, s[24:27], s70 offen offset:1024 nt
    buffer_load_dwordx4 v[92:95], v3, s[32:35], s57 offen offset:1024
    v_and_b32_dpp v24, v37, v4 row_newbcast:0 row_mask:0xf bank_mask:0xf
    v_and_b32_dpp v25, v37, v5 row_newbcast:0 row_mask:0xf bank_mask:0xf
    v_and_b32_dpp v26, v37, v6 row_newbcast:0 row_mask:0xf bank_mask:0xf
    v_and_b32_dpp v27, v37, v7 row_newbcast:0 row_mask:0xf bank_mask:0xf
    s_waitcnt vmcnt(10)
    s_nop 0
    v_mfma_f32_16x16x32_bf16 v[32:35], v[188:191], v[24:27], v[32:35]
    buffer_load_dwordx4 v[164:167], v1, s[24:27], s70 offen offset:2048 nt
    s_add_u32 s57, s57, 5120
    buffer_load_dwordx4 v[96:99], v3, s[32:35], s57 offen offset:0
    v_and_b32_dpp v28, v37, v4 row_newbcast:8 row_mask:0xf bank_mask:0xf
    v_and_b32_dpp v29, v37, v5 row_newbcast:8 row_mask:0xf bank_mask:0xf
    v_and_b32_dpp v30, v37, v6 row_newbcast:8 row_mask:0xf bank_mask:0xf
    v_and_b32_dpp v31, v37, v7 row_newbcast:8 row_mask:0xf bank_mask:0xf
    s_waitcnt vmcnt(11)
    s_nop 0
    v_mfma_f32_16x16x32_bf16 v[32:35], v[192:195], v[28:31], v[32:35]
    buffer_load_dwordx4 v[168:171], v1, s[24:27], s70 offen offset:3072 nt
    buffer_load_dwordx4 v[100:103], v3, s[32:35], s57 offen offset:256
    v_and_b32_dpp v24, v37, v4 row_newbcast:4 row_mask:0xf bank_mask:0xf
    v_and_b32_dpp v25, v37, v5 row_newbcast:4 row_mask:0xf bank_mask:0xf
    v_and_b32_dpp v26, v37, v6 row_newbcast:4 row_mask:0xf bank_mask:0xf
    v_and_b32_dpp v27, v37, v7 row_newbcast:4 row_mask:0xf bank_mask:0xf
    s_waitcnt vmcnt(11)
    s_nop 0
    v_mfma_f32_16x16x32_bf16 v[32:35], v[196:199], v[24:27], v[32:35]
    buffer_load_dwordx4 v[172:175], v1, s[24:27], s71 offen offset:0 nt
    buffer_load_dwordx4 v[104:107], v3, s[32:35], s57 offen offset:512
    v_and_b32_dpp v28, v37, v4 row_newbcast:12 row_mask:0xf bank_mask:0xf
    v_and_b32_dpp v29, v37, v5 row_newbcast:12 row_mask:0xf bank_mask:0xf
    v_and_b32_dpp v30, v37, v6 row_newbcast:12 row_mask:0xf bank_mask:0xf
    v_and_b32_dpp v31, v37, v7 row_newbcast:12 row_mask:0xf bank_mask:0xf
    s_waitcnt vmcnt(11)
    s_nop 0
    v_mfma_f32_16x16x32_bf16 v[32:35], v[200:203], v[28:31], v[32:35]
    buffer_load_dwordx4 v[176:179], v1, s[24:27], s71 offen offset:1024 nt
    buffer_load_dwordx4 v[108:111], v3, s[32:35], s57 offen offset:768
    v_and_b32_dpp v24, v38, v4 row_newbcast:0 row_mask:0xf bank_mask:0xf
    v_and_b32_dpp v25, v38, v5 row_newbcast:0 row_mask:0xf bank_mask:0xf
    v_and_b32_dpp v26, v38, v6 row_newbcast:0 row_mask:0xf bank_mask:0xf
    v_and_b32_dpp v27, v38, v7 row_newbcast:0 row_mask:0xf bank_mask:0xf
    s_waitcnt vmcnt(11)
    s_nop 0
    v_mfma_f32_16x16x32_bf16 v[32:35], v[156:159], v[24:27], v[32:35]
    buffer_load_dwordx4 v[180:183], v1, s[24:27], s71 offen offset:2048 nt
    buffer_load_dwordx4 v[112:115], v3, s[32:35], s57 offen offset:1024
    v_and_b32_dpp v28, v38, v4 row_newbcast:8 row_mask:0xf bank_mask:0xf
    v_and_b32_dpp v29, v38, v5 row_newbcast:8 row_mask:0xf bank_mask:0xf
    v_and_b32_dpp v30, v38, v6 row_newbcast:8 row_mask:0xf bank_mask:0xf
    v_and_b32_dpp v31, v38, v7 row_newbcast:8 row_mask:0xf bank_mask:0xf
    s_waitcnt vmcnt(11)
    s_nop 0
    v_mfma_f32_16x16x32_bf16 v[32:35], v[160:163], v[28:31], v[32:35]
    buffer_load_dwordx4 v[184:187], v1, s[24:27], s71 offen offset:3072 nt
    s_add_u32 s57, s57, 5120
    buffer_load_dwordx4 v[116:119], v3, s[32:35], s57 offen offset:0
    v_and_b32_dpp v24, v38, v4 row_newbcast:4 row_mask:0xf bank_mask:0xf
    v_and_b32_dpp v25, v38, v5 row_newbcast:4 row_mask:0xf bank_mask:0xf
    v_and_b32_dpp v26, v38, v6 row_newbcast:4 row_mask:0xf bank_mask:0xf
    v_and_b32_dpp v27, v38, v7 row_newbcast:4 row_mask:0xf bank_mask:0xf
    s_waitcnt vmcnt(11)
    s_nop 0
    v_mfma_f32_16x16x32_bf16 v[32:35], v[164:167], v[24:27], v[32:35]
    buffer_load_dwordx4 v[188:191], v1, s[24:27], s72 offen offset:0 nt
    buffer_load_dwordx4 v[120:123], v3, s[32:35], s57 offen offset:256
    v_and_b32_dpp v28, v38, v4 row_newbcast:12 row_mask:0xf bank_mask:0xf
    v_and_b32_dpp v29, v38, v5 row_newbcast:12 row_mask:0xf bank_mask:0xf
    v_and_b32_dpp v30, v38, v6 row_newbcast:12 row_mask:0xf bank_mask:0xf
    v_and_b32_dpp v31, v38, v7 row_newbcast:12 row_mask:0xf bank_mask:0xf
    s_waitcnt vmcnt(11)
    s_nop 0
    v_mfma_f32_16x16x32_bf16 v[32:35], v[168:171], v[28:31], v[32:35]
    buffer_load_dwordx4 v[192:195], v1, s[24:27], s72 offen offset:1024 nt
    buffer_load_dwordx4 v[124:127], v3, s[32:35], s57 offen offset:512
    v_and_b32_dpp v24, v39, v4 row_newbcast:0 row_mask:0xf bank_mask:0xf
    v_and_b32_dpp v25, v39, v5 row_newbcast:0 row_mask:0xf bank_mask:0xf
    v_and_b32_dpp v26, v39, v6 row_newbcast:0 row_mask:0xf bank_mask:0xf
    v_and_b32_dpp v27, v39, v7 row_newbcast:0 row_mask:0xf bank_mask:0xf
    s_waitcnt vmcnt(11)
    s_nop 0
    v_mfma_f32_16x16x32_bf16 v[32:35], v[172:175], v[24:27], v[32:35]
    buffer_load_dwordx4 v[196:199], v1, s[24:27], s72 offen offset:2048 nt
    buffer_load_dwordx4 v[128:131], v3, s[32:35], s57 offen offset:768
    v_and_b32_dpp v28, v39, v4 row_newbcast:8 row_mask:0xf bank_mask:0xf
    v_and_b32_dpp v29, v39, v5 row_newbcast:8 row_mask:0xf bank_mask:0xf
    v_and_b32_dpp v30, v39, v6 row_newbcast:8 row_mask:0xf bank_mask:0xf
    v_and_b32_dpp v31, v39, v7 row_newbcast:8 row_mask:0xf bank_mask:0xf
    s_waitcnt vmcnt(11)
    s_nop 0
    v_mfma_f32_16x16x32_bf16 v[32:35], v[176:179], v[28:31], v[32:35]
    buffer_load_dwordx4 v[200:203], v1, s[24:27], s72 offen offset:3072 nt
    buffer_load_dwordx4 v[132:135], v3, s[32:35], s57 offen offset:1024
    v_and_b32_dpp v24, v39, v4 row_newbcast:4 row_mask:0xf bank_mask:0xf
    v_and_b32_dpp v25, v39, v5 row_newbcast:4 row_mask:0xf bank_mask:0xf
    v_and_b32_dpp v26, v39, v6 row_newbcast:4 row_mask:0xf bank_mask:0xf
    v_and_b32_dpp v27, v39, v7 row_newbcast:4 row_mask:0xf bank_mask:0xf
    s_waitcnt vmcnt(11)
    s_nop 0
    v_mfma_f32_16x16x32_bf16 v[32:35], v[180:183], v[24:27], v[32:35]
    buffer_load_dwordx4 v[156:159], v1, s[24:27], s73 offen offset:0 nt
    s_add_u32 s57, s57, 5120
    buffer_load_dwordx4 v[136:139], v3, s[32:35], s57 offen offset:0
    v_and_b32_dpp v28, v39, v4 row_newbcast:12 row_mask:0xf bank_mask:0xf
    v_and_b32_dpp v29, v39, v5 row_newbcast:12 row_mask:0xf bank_mask:0xf
    v_and_b32_dpp v30, v39, v6 row_newbcast:12 row_mask:0xf bank_mask:0xf
    v_and_b32_dpp v31, v39, v7 row_newbcast:12 row_mask:0xf bank_mask:0xf
    s_waitcnt vmcnt(11)
    s_nop 0
    v_mfma_f32_16x16x32_bf16 v[32:35], v[184:187], v[28:31], v[32:35]
    buffer_load_dwordx4 v[160:163], v1, s[24:27], s73 offen offset:1024 nt
    buffer_load_dwordx4 v[140:143], v3, s[32:35], s57 offen offset:256
    v_and_b32_dpp v24, v40, v4 row_newbcast:0 row_mask:0xf bank_mask:0xf
    v_and_b32_dpp v25, v40, v5 row_newbcast:0 row_mask:0xf bank_mask:0xf
    v_and_b32_dpp v26, v40, v6 row_newbcast:0 row_mask:0xf bank_mask:0xf
    v_and_b32_dpp v27, v40, v7 row_newbcast:0 row_mask:0xf bank_mask:0xf
    s_waitcnt vmcnt(11)
    s_nop 0
    v_mfma_f32_16x16x32_bf16 v[32:35], v[188:191], v[24:27], v[32:35]
    buffer_load_dwordx4 v[164:167], v1, s[24:27], s73 offen offset:2048 nt
    buffer_load_dwordx4 v[144:147], v3, s[32:35], s57 offen offset:512
    v_and_b32_dpp v28, v40, v4 row_newbcast:8 row_mask:0xf bank_mask:0xf
    v_and_b32_dpp v29, v40, v5 row_newbcast:8 row_mask:0xf bank_mask:0xf
    v_and_b32_dpp v30, v40, v6 row_newbcast:8 row_mask:0xf bank_mask:0xf
    v_and_b32_dpp v31, v40, v7 row_newbcast:8 row_mask:0xf bank_mask:0xf
    s_waitcnt vmcnt(11)
    s_nop 0
    v_mfma_f32_16x16x32_bf16 v[32:35], v[192:195], v[28:31], v[32:35]
    buffer_load_dwordx4 v[168:171], v1, s[24:27], s73 offen offset:3072 nt
    buffer_load_dwordx4 v[148:151], v3, s[32:35], s57 offen offset:768
    v_and_b32_dpp v24, v40, v4 row_newbcast:4 row_mask:0xf bank_mask:0xf
    v_and_b32_dpp v25, v40, v5 row_newbcast:4 row_mask:0xf bank_mask:0xf
    v_and_b32_dpp v26, v40, v6 row_newbcast:4 row_mask:0xf bank_mask:0xf
    v_and_b32_dpp v27, v40, v7 row_newbcast:4 row_mask:0xf bank_mask:0xf
    s_waitcnt vmcnt(11)
    s_nop 0
    v_mfma_f32_16x16x32_bf16 v[32:35], v[196:199], v[24:27], v[32:35]
    buffer_load_dwordx4 v[172:175], v1, s[24:27], s74 offen offset:0 nt
    buffer_load_dwordx4 v[152:155], v3, s[32:35], s57 offen offset:1024
    v_and_b32_dpp v28, v40, v4 row_newbcast:12 row_mask:0xf bank_mask:0xf
    v_and_b32_dpp v29, v40, v5 row_newbcast:12 row_mask:0xf bank_mask:0xf
    v_and_b32_dpp v30, v40, v6 row_newbcast:12 row_mask:0xf bank_mask:0xf
    v_and_b32_dpp v31, v40, v7 row_newbcast:12 row_mask:0xf bank_mask:0xf
    s_waitcnt vmcnt(11)
    s_nop 0
    v_mfma_f32_16x16x32_bf16 v[32:35], v[200:203], v[28:31], v[32:35]
    buffer_load_dwordx4 v[176:179], v1, s[24:27], s74 offen offset:1024 nt
    v_and_b32_dpp v24, v41, v4 row_newbcast:0 row_mask:0xf bank_mask:0xf
    v_and_b32_dpp v25, v41, v5 row_newbcast:0 row_mask:0xf bank_mask:0xf
    v_and_b32_dpp v26, v41, v6 row_newbcast:0 row_mask:0xf bank_mask:0xf
    v_and_b32_dpp v27, v41, v7 row_newbcast:0 row_mask:0xf bank_mask:0xf
    s_waitcnt vmcnt(10)
    s_nop 0
    v_mfma_f32_16x16x32_bf16 v[32:35], v[156:159], v[24:27], v[32:35]
    buffer_load_dwordx4 v[180:183], v1, s[24:27], s74 offen offset:2048 nt
    v_and_b32_dpp v28, v41, v4 row_newbcast:8 row_mask:0xf bank_mask:0xf
    v_and_b32_dpp v29, v41, v5 row_newbcast:8 row_mask:0xf bank_mask:0xf
    v_and_b32_dpp v30, v41, v6 row_newbcast:8 row_mask:0xf bank_mask:0xf
    v_and_b32_dpp v31, v41, v7 row_newbcast:8 row_mask:0xf bank_mask:0xf
    s_waitcnt vmcnt(9)
    s_nop 0
    v_mfma_f32_16x16x32_bf16 v[32:35], v[160:163], v[28:31], v[32:35]
    buffer_load_dwordx4 v[184:187], v1, s[24:27], s74 offen offset:3072 nt
    v_and_b32_dpp v24, v41, v4 row_newbcast:4 row_mask:0xf bank_mask:0xf
    v_and_b32_dpp v25, v41, v5 row_newbcast:4 row_mask:0xf bank_mask:0xf
    v_and_b32_dpp v26, v41, v6 row_newbcast:4 row_mask:0xf bank_mask:0xf
    v_and_b32_dpp v27, v41, v7 row_newbcast:4 row_mask:0xf bank_mask:0xf
    s_waitcnt vmcnt(8)
    s_nop 0
    v_mfma_f32_16x16x32_bf16 v[32:35], v[164:167], v[24:27], v[32:35]
    buffer_load_dwordx4 v[188:191], v1, s[24:27], s75 offen offset:0 nt
    v_and_b32_dpp v28, v41, v4 row_newbcast:12 row_mask:0xf bank_mask:0xf
    v_and_b32_dpp v29, v41, v5 row_newbcast:12 row_mask:0xf bank_mask:0xf
    v_and_b32_dpp v30, v41, v6 row_newbcast:12 row_mask:0xf bank_mask:0xf
    v_and_b32_dpp v31, v41, v7 row_newbcast:12 row_mask:0xf bank_mask:0xf
    s_waitcnt vmcnt(7)
    s_nop 0
    v_mfma_f32_16x16x32_bf16 v[32:35], v[168:171], v[28:31], v[32:35]
    buffer_load_dwordx4 v[192:195], v1, s[24:27], s75 offen offset:1024 nt
    v_and_b32_dpp v24, v42, v4 row_newbcast:0 row_mask:0xf bank_mask:0xf
    v_and_b32_dpp v25, v42, v5 row_newbcast:0 row_mask:0xf bank_mask:0xf
    v_and_b32_dpp v26, v42, v6 row_newbcast:0 row_mask:0xf bank_mask:0xf
    v_and_b32_dpp v27, v42, v7 row_newbcast:0 row_mask:0xf bank_mask:0xf
    s_waitcnt vmcnt(6)
    s_nop 0
    v_mfma_f32_16x16x32_bf16 v[32:35], v[172:175], v[24:27], v[32:35]
    buffer_load_dwordx4 v[196:199], v1, s[24:27], s75 offen offset:2048 nt
    v_and_b32_dpp v28, v42, v4 row_newbcast:8 row_mask:0xf bank_mask:0xf
    v_and_b32_dpp v29, v42, v5 row_newbcast:8 row_mask:0xf bank_mask:0xf
    v_and_b32_dpp v30, v42, v6 row_newbcast:8 row_mask:0xf bank_mask:0xf
    v_and_b32_dpp v31, v42, v7 row_newbcast:8 row_mask:0xf bank_mask:0xf
    s_waitcnt vmcnt(5)
    s_nop 0
    v_mfma_f32_16x16x32_bf16 v[32:35], v[176:179], v[28:31], v[32:35]
    buffer_load_dwordx4 v[200:203], v1, s[24:27], s75 offen offset:3072 nt
    v_and_b32_dpp v24, v42, v4 row_newbcast:4 row_mask:0xf bank_mask:0xf
    v_and_b32_dpp v25, v42, v5 row_newbcast:4 row_mask:0xf bank_mask:0xf
    v_and_b32_dpp v26, v42, v6 row_newbcast:4 row_mask:0xf bank_mask:0xf
    v_and_b32_dpp v27, v42, v7 row_newbcast:4 row_mask:0xf bank_mask:0xf
    s_waitcnt vmcnt(5)
    s_nop 0
    v_mfma_f32_16x16x32_bf16 v[32:35], v[180:183], v[24:27], v[32:35]
    buffer_load_dwordx4 v[156:159], v1, s[24:27], s76 offen offset:0 nt
    v_and_b32_dpp v28, v42, v4 row_newbcast:12 row_mask:0xf bank_mask:0xf
    v_and_b32_dpp v29, v42, v5 row_newbcast:12 row_mask:0xf bank_mask:0xf
    v_and_b32_dpp v30, v42, v6 row_newbcast:12 row_mask:0xf bank_mask:0xf
    v_and_b32_dpp v31, v42, v7 row_newbcast:12 row_mask:0xf bank_mask:0xf
    s_waitcnt vmcnt(5)
    s_nop 0
    v_mfma_f32_16x16x32_bf16 v[32:35], v[184:187], v[28:31], v[32:35]
    buffer_load_dwordx4 v[160:163], v1, s[24:27], s76 offen offset:1024 nt
    v_and_b32_dpp v24, v43, v4 row_newbcast:0 row_mask:0xf bank_mask:0xf
    v_and_b32_dpp v25, v43, v5 row_newbcast:0 row_mask:0xf bank_mask:0xf
    v_and_b32_dpp v26, v43, v6 row_newbcast:0 row_mask:0xf bank_mask:0xf
    v_and_b32_dpp v27, v43, v7 row_newbcast:0 row_mask:0xf bank_mask:0xf
    s_waitcnt vmcnt(5)
    s_nop 0
    v_mfma_f32_16x16x32_bf16 v[32:35], v[188:191], v[24:27], v[32:35]
    buffer_load_dwordx4 v[164:167], v1, s[24:27], s76 offen offset:2048 nt
    v_and_b32_dpp v28, v43, v4 row_newbcast:8 row_mask:0xf bank_mask:0xf
    v_and_b32_dpp v29, v43, v5 row_newbcast:8 row_mask:0xf bank_mask:0xf
    v_and_b32_dpp v30, v43, v6 row_newbcast:8 row_mask:0xf bank_mask:0xf
    v_and_b32_dpp v31, v43, v7 row_newbcast:8 row_mask:0xf bank_mask:0xf
    s_waitcnt vmcnt(5)
    s_nop 0
    v_mfma_f32_16x16x32_bf16 v[32:35], v[192:195], v[28:31], v[32:35]
    buffer_load_dwordx4 v[168:171], v1, s[24:27], s76 offen offset:3072 nt
    v_and_b32_dpp v24, v43, v4 row_newbcast:4 row_mask:0xf bank_mask:0xf
    v_and_b32_dpp v25, v43, v5 row_newbcast:4 row_mask:0xf bank_mask:0xf
    v_and_b32_dpp v26, v43, v6 row_newbcast:4 row_mask:0xf bank_mask:0xf
    v_and_b32_dpp v27, v43, v7 row_newbcast:4 row_mask:0xf bank_mask:0xf
    s_waitcnt vmcnt(5)
    s_nop 0
    v_mfma_f32_16x16x32_bf16 v[32:35], v[196:199], v[24:27], v[32:35]
    buffer_load_dwordx4 v[172:175], v1, s[24:27], s77 offen offset:0 nt
    v_and_b32_dpp v28, v43, v4 row_newbcast:12 row_mask:0xf bank_mask:0xf
    v_and_b32_dpp v29, v43, v5 row_newbcast:12 row_mask:0xf bank_mask:0xf
    v_and_b32_dpp v30, v43, v6 row_newbcast:12 row_mask:0xf bank_mask:0xf
    v_and_b32_dpp v31, v43, v7 row_newbcast:12 row_mask:0xf bank_mask:0xf
    s_waitcnt vmcnt(5)
    s_nop 0
    v_mfma_f32_16x16x32_bf16 v[32:35], v[200:203], v[28:31], v[32:35]
    buffer_load_dwordx4 v[176:179], v1, s[24:27], s77 offen offset:1024 nt
    v_and_b32_dpp v24, v44, v4 row_newbcast:0 row_mask:0xf bank_mask:0xf
    v_and_b32_dpp v25, v44, v5 row_newbcast:0 row_mask:0xf bank_mask:0xf
    v_and_b32_dpp v26, v44, v6 row_newbcast:0 row_mask:0xf bank_mask:0xf
    v_and_b32_dpp v27, v44, v7 row_newbcast:0 row_mask:0xf bank_mask:0xf
    s_waitcnt vmcnt(5)
    s_nop 0
    v_mfma_f32_16x16x32_bf16 v[32:35], v[156:159], v[24:27], v[32:35]
    buffer_load_dwordx4 v[180:183], v1, s[24:27], s77 offen offset:2048 nt
    v_and_b32_dpp v28, v44, v4 row_newbcast:8 row_mask:0xf bank_mask:0xf
    v_and_b32_dpp v29, v44, v5 row_newbcast:8 row_mask:0xf bank_mask:0xf
    v_and_b32_dpp v30, v44, v6 row_newbcast:8 row_mask:0xf bank_mask:0xf
    v_and_b32_dpp v31, v44, v7 row_newbcast:8 row_mask:0xf bank_mask:0xf
    s_waitcnt vmcnt(5)
    s_nop 0
    v_mfma_f32_16x16x32_bf16 v[32:35], v[160:163], v[28:31], v[32:35]
    buffer_load_dwordx4 v[184:187], v1, s[24:27], s77 offen offset:3072 nt
    v_and_b32_dpp v24, v44, v4 row_newbcast:4 row_mask:0xf bank_mask:0xf
    v_and_b32_dpp v25, v44, v5 row_newbcast:4 row_mask:0xf bank_mask:0xf
    v_and_b32_dpp v26, v44, v6 row_newbcast:4 row_mask:0xf bank_mask:0xf
    v_and_b32_dpp v27, v44, v7 row_newbcast:4 row_mask:0xf bank_mask:0xf
    s_waitcnt vmcnt(5)
    s_nop 0
    v_mfma_f32_16x16x32_bf16 v[32:35], v[164:167], v[24:27], v[32:35]
    buffer_load_dwordx4 v[188:191], v1, s[24:27], s78 offen offset:0 nt
    v_and_b32_dpp v28, v44, v4 row_newbcast:12 row_mask:0xf bank_mask:0xf
    v_and_b32_dpp v29, v44, v5 row_newbcast:12 row_mask:0xf bank_mask:0xf
    v_and_b32_dpp v30, v44, v6 row_newbcast:12 row_mask:0xf bank_mask:0xf
    v_and_b32_dpp v31, v44, v7 row_newbcast:12 row_mask:0xf bank_mask:0xf
    s_waitcnt vmcnt(5)
    s_nop 0
    v_mfma_f32_16x16x32_bf16 v[32:35], v[168:171], v[28:31], v[32:35]
    buffer_load_dwordx4 v[192:195], v1, s[24:27], s78 offen offset:1024 nt
    v_and_b32_dpp v24, v45, v4 row_newbcast:0 row_mask:0xf bank_mask:0xf
    v_and_b32_dpp v25, v45, v5 row_newbcast:0 row_mask:0xf bank_mask:0xf
    v_and_b32_dpp v26, v45, v6 row_newbcast:0 row_mask:0xf bank_mask:0xf
    v_and_b32_dpp v27, v45, v7 row_newbcast:0 row_mask:0xf bank_mask:0xf
    s_waitcnt vmcnt(5)
    s_nop 0
    v_mfma_f32_16x16x32_bf16 v[32:35], v[172:175], v[24:27], v[32:35]
    buffer_load_dwordx4 v[196:199], v1, s[24:27], s78 offen offset:2048 nt
    v_and_b32_dpp v28, v45, v4 row_newbcast:8 row_mask:0xf bank_mask:0xf
    v_and_b32_dpp v29, v45, v5 row_newbcast:8 row_mask:0xf bank_mask:0xf
    v_and_b32_dpp v30, v45, v6 row_newbcast:8 row_mask:0xf bank_mask:0xf
    v_and_b32_dpp v31, v45, v7 row_newbcast:8 row_mask:0xf bank_mask:0xf
    s_waitcnt vmcnt(5)
    s_nop 0
    v_mfma_f32_16x16x32_bf16 v[32:35], v[176:179], v[28:31], v[32:35]
    buffer_load_dwordx4 v[200:203], v1, s[24:27], s78 offen offset:3072 nt
    v_and_b32_dpp v24, v45, v4 row_newbcast:4 row_mask:0xf bank_mask:0xf
    v_and_b32_dpp v25, v45, v5 row_newbcast:4 row_mask:0xf bank_mask:0xf
    v_and_b32_dpp v26, v45, v6 row_newbcast:4 row_mask:0xf bank_mask:0xf
    v_and_b32_dpp v27, v45, v7 row_newbcast:4 row_mask:0xf bank_mask:0xf
    s_waitcnt vmcnt(5)
    s_nop 0
    v_mfma_f32_16x16x32_bf16 v[32:35], v[180:183], v[24:27], v[32:35]
    buffer_load_dwordx4 v[156:159], v1, s[24:27], s79 offen offset:0 nt
    v_and_b32_dpp v28, v45, v4 row_newbcast:12 row_mask:0xf bank_mask:0xf
    v_and_b32_dpp v29, v45, v5 row_newbcast:12 row_mask:0xf bank_mask:0xf
    v_and_b32_dpp v30, v45, v6 row_newbcast:12 row_mask:0xf bank_mask:0xf
    v_and_b32_dpp v31, v45, v7 row_newbcast:12 row_mask:0xf bank_mask:0xf
    s_waitcnt vmcnt(5)
    s_nop 0
    v_mfma_f32_16x16x32_bf16 v[32:35], v[184:187], v[28:31], v[32:35]
    buffer_load_dwordx4 v[160:163], v1, s[24:27], s79 offen offset:1024 nt
    v_and_b32_dpp v24, v46, v4 row_newbcast:0 row_mask:0xf bank_mask:0xf
    v_and_b32_dpp v25, v46, v5 row_newbcast:0 row_mask:0xf bank_mask:0xf
    v_and_b32_dpp v26, v46, v6 row_newbcast:0 row_mask:0xf bank_mask:0xf
    v_and_b32_dpp v27, v46, v7 row_newbcast:0 row_mask:0xf bank_mask:0xf
    s_waitcnt vmcnt(5)
    s_nop 0
    v_mfma_f32_16x16x32_bf16 v[32:35], v[188:191], v[24:27], v[32:35]
    buffer_load_dwordx4 v[164:167], v1, s[24:27], s79 offen offset:2048 nt
    v_and_b32_dpp v28, v46, v4 row_newbcast:8 row_mask:0xf bank_mask:0xf
    v_and_b32_dpp v29, v46, v5 row_newbcast:8 row_mask:0xf bank_mask:0xf
    v_and_b32_dpp v30, v46, v6 row_newbcast:8 row_mask:0xf bank_mask:0xf
    v_and_b32_dpp v31, v46, v7 row_newbcast:8 row_mask:0xf bank_mask:0xf
    s_waitcnt vmcnt(5)
    s_nop 0
    v_mfma_f32_16x16x32_bf16 v[32:35], v[192:195], v[28:31], v[32:35]
    buffer_load_dwordx4 v[168:171], v1, s[24:27], s79 offen offset:3072 nt
    v_and_b32_dpp v24, v46, v4 row_newbcast:4 row_mask:0xf bank_mask:0xf
    v_and_b32_dpp v25, v46, v5 row_newbcast:4 row_mask:0xf bank_mask:0xf
    v_and_b32_dpp v26, v46, v6 row_newbcast:4 row_mask:0xf bank_mask:0xf
    v_and_b32_dpp v27, v46, v7 row_newbcast:4 row_mask:0xf bank_mask:0xf
    s_waitcnt vmcnt(5)
    s_nop 0
    v_mfma_f32_16x16x32_bf16 v[32:35], v[196:199], v[24:27], v[32:35]
    buffer_load_dwordx4 v[172:175], v1, s[24:27], s80 offen offset:0 nt
    v_and_b32_dpp v28, v46, v4 row_newbcast:12 row_mask:0xf bank_mask:0xf
    v_and_b32_dpp v29, v46, v5 row_newbcast:12 row_mask:0xf bank_mask:0xf
    v_and_b32_dpp v30, v46, v6 row_newbcast:12 row_mask:0xf bank_mask:0xf
    v_and_b32_dpp v31, v46, v7 row_newbcast:12 row_mask:0xf bank_mask:0xf
    s_waitcnt vmcnt(5)
    s_nop 0
    v_mfma_f32_16x16x32_bf16 v[32:35], v[200:203], v[28:31], v[32:35]
    buffer_load_dwordx4 v[176:179], v1, s[24:27], s80 offen offset:1024 nt
    v_and_b32_dpp v24, v47, v4 row_newbcast:0 row_mask:0xf bank_mask:0xf
    v_and_b32_dpp v25, v47, v5 row_newbcast:0 row_mask:0xf bank_mask:0xf
    v_and_b32_dpp v26, v47, v6 row_newbcast:0 row_mask:0xf bank_mask:0xf
    v_and_b32_dpp v27, v47, v7 row_newbcast:0 row_mask:0xf bank_mask:0xf
    s_waitcnt vmcnt(5)
    s_nop 0
    v_mfma_f32_16x16x32_bf16 v[32:35], v[156:159], v[24:27], v[32:35]
    buffer_load_dwordx4 v[180:183], v1, s[24:27], s80 offen offset:2048 nt
    v_and_b32_dpp v28, v47, v4 row_newbcast:8 row_mask:0xf bank_mask:0xf
    v_and_b32_dpp v29, v47, v5 row_newbcast:8 row_mask:0xf bank_mask:0xf
    v_and_b32_dpp v30, v47, v6 row_newbcast:8 row_mask:0xf bank_mask:0xf
    v_and_b32_dpp v31, v47, v7 row_newbcast:8 row_mask:0xf bank_mask:0xf
    s_waitcnt vmcnt(5)
    s_nop 0
    v_mfma_f32_16x16x32_bf16 v[32:35], v[160:163], v[28:31], v[32:35]
    buffer_load_dwordx4 v[184:187], v1, s[24:27], s80 offen offset:3072 nt
    v_and_b32_dpp v24, v47, v4 row_newbcast:4 row_mask:0xf bank_mask:0xf
    v_and_b32_dpp v25, v47, v5 row_newbcast:4 row_mask:0xf bank_mask:0xf
    v_and_b32_dpp v26, v47, v6 row_newbcast:4 row_mask:0xf bank_mask:0xf
    v_and_b32_dpp v27, v47, v7 row_newbcast:4 row_mask:0xf bank_mask:0xf
    s_waitcnt vmcnt(5)
    s_nop 0
    v_mfma_f32_16x16x32_bf16 v[32:35], v[164:167], v[24:27], v[32:35]
    buffer_load_dwordx4 v[188:191], v1, s[24:27], s81 offen offset:0 nt
    v_and_b32_dpp v28, v47, v4 row_newbcast:12 row_mask:0xf bank_mask:0xf
    v_and_b32_dpp v29, v47, v5 row_newbcast:12 row_mask:0xf bank_mask:0xf
    v_and_b32_dpp v30, v47, v6 row_newbcast:12 row_mask:0xf bank_mask:0xf
    v_and_b32_dpp v31, v47, v7 row_newbcast:12 row_mask:0xf bank_mask:0xf
    s_waitcnt vmcnt(5)
    s_nop 0
    v_mfma_f32_16x16x32_bf16 v[32:35], v[168:171], v[28:31], v[32:35]
    buffer_load_dwordx4 v[192:195], v1, s[24:27], s81 offen offset:1024 nt
    v_and_b32_dpp v24, v48, v4 row_newbcast:0 row_mask:0xf bank_mask:0xf
    v_and_b32_dpp v25, v48, v5 row_newbcast:0 row_mask:0xf bank_mask:0xf
    v_and_b32_dpp v26, v48, v6 row_newbcast:0 row_mask:0xf bank_mask:0xf
    v_and_b32_dpp v27, v48, v7 row_newbcast:0 row_mask:0xf bank_mask:0xf
    s_waitcnt vmcnt(5)
    s_nop 0
    v_mfma_f32_16x16x32_bf16 v[32:35], v[172:175], v[24:27], v[32:35]
    buffer_load_dwordx4 v[196:199], v1, s[24:27], s81 offen offset:2048 nt
    v_and_b32_dpp v28, v48, v4 row_newbcast:8 row_mask:0xf bank_mask:0xf
    v_and_b32_dpp v29, v48, v5 row_newbcast:8 row_mask:0xf bank_mask:0xf
    v_and_b32_dpp v30, v48, v6 row_newbcast:8 row_mask:0xf bank_mask:0xf
    v_and_b32_dpp v31, v48, v7 row_newbcast:8 row_mask:0xf bank_mask:0xf
    s_waitcnt vmcnt(5)
    s_nop 0
    v_mfma_f32_16x16x32_bf16 v[32:35], v[176:179], v[28:31], v[32:35]
    buffer_load_dwordx4 v[200:203], v1, s[24:27], s81 offen offset:3072 nt
    v_and_b32_dpp v24, v48, v4 row_newbcast:4 row_mask:0xf bank_mask:0xf
    v_and_b32_dpp v25, v48, v5 row_newbcast:4 row_mask:0xf bank_mask:0xf
    v_and_b32_dpp v26, v48, v6 row_newbcast:4 row_mask:0xf bank_mask:0xf
    v_and_b32_dpp v27, v48, v7 row_newbcast:4 row_mask:0xf bank_mask:0xf
    s_waitcnt vmcnt(5)
    s_nop 0
    v_mfma_f32_16x16x32_bf16 v[32:35], v[180:183], v[24:27], v[32:35]
    buffer_load_dwordx4 v[156:159], v1, s[24:27], s82 offen offset:0 nt
    v_and_b32_dpp v28, v48, v4 row_newbcast:12 row_mask:0xf bank_mask:0xf
    v_and_b32_dpp v29, v48, v5 row_newbcast:12 row_mask:0xf bank_mask:0xf
    v_and_b32_dpp v30, v48, v6 row_newbcast:12 row_mask:0xf bank_mask:0xf
    v_and_b32_dpp v31, v48, v7 row_newbcast:12 row_mask:0xf bank_mask:0xf
    s_waitcnt vmcnt(5)
    s_nop 0
    v_mfma_f32_16x16x32_bf16 v[32:35], v[184:187], v[28:31], v[32:35]
    buffer_load_dwordx4 v[160:163], v1, s[24:27], s82 offen offset:1024 nt
    v_and_b32_dpp v24, v49, v4 row_newbcast:0 row_mask:0xf bank_mask:0xf
    v_and_b32_dpp v25, v49, v5 row_newbcast:0 row_mask:0xf bank_mask:0xf
    v_and_b32_dpp v26, v49, v6 row_newbcast:0 row_mask:0xf bank_mask:0xf
    v_and_b32_dpp v27, v49, v7 row_newbcast:0 row_mask:0xf bank_mask:0xf
    s_waitcnt vmcnt(5)
    s_nop 0
    v_mfma_f32_16x16x32_bf16 v[32:35], v[188:191], v[24:27], v[32:35]
    buffer_load_dwordx4 v[164:167], v1, s[24:27], s82 offen offset:2048 nt
    v_and_b32_dpp v28, v49, v4 row_newbcast:8 row_mask:0xf bank_mask:0xf
    v_and_b32_dpp v29, v49, v5 row_newbcast:8 row_mask:0xf bank_mask:0xf
    v_and_b32_dpp v30, v49, v6 row_newbcast:8 row_mask:0xf bank_mask:0xf
    v_and_b32_dpp v31, v49, v7 row_newbcast:8 row_mask:0xf bank_mask:0xf
    s_waitcnt vmcnt(5)
    s_nop 0
    v_mfma_f32_16x16x32_bf16 v[32:35], v[192:195], v[28:31], v[32:35]
    buffer_load_dwordx4 v[168:171], v1, s[24:27], s82 offen offset:3072 nt
    v_and_b32_dpp v24, v49, v4 row_newbcast:4 row_mask:0xf bank_mask:0xf
    v_and_b32_dpp v25, v49, v5 row_newbcast:4 row_mask:0xf bank_mask:0xf
    v_and_b32_dpp v26, v49, v6 row_newbcast:4 row_mask:0xf bank_mask:0xf
    v_and_b32_dpp v27, v49, v7 row_newbcast:4 row_mask:0xf bank_mask:0xf
    s_waitcnt vmcnt(5)
    s_nop 0
    v_mfma_f32_16x16x32_bf16 v[32:35], v[196:199], v[24:27], v[32:35]
    buffer_load_dwordx4 v[172:175], v1, s[24:27], s83 offen offset:0 nt
    v_and_b32_dpp v28, v49, v4 row_newbcast:12 row_mask:0xf bank_mask:0xf
    v_and_b32_dpp v29, v49, v5 row_newbcast:12 row_mask:0xf bank_mask:0xf
    v_and_b32_dpp v30, v49, v6 row_newbcast:12 row_mask:0xf bank_mask:0xf
    v_and_b32_dpp v31, v49, v7 row_newbcast:12 row_mask:0xf bank_mask:0xf
    s_waitcnt vmcnt(5)
    s_nop 0
    v_mfma_f32_16x16x32_bf16 v[32:35], v[200:203], v[28:31], v[32:35]
    buffer_load_dwordx4 v[176:179], v1, s[24:27], s83 offen offset:1024 nt
    v_and_b32_dpp v24, v50, v4 row_newbcast:0 row_mask:0xf bank_mask:0xf
    v_and_b32_dpp v25, v50, v5 row_newbcast:0 row_mask:0xf bank_mask:0xf
    v_and_b32_dpp v26, v50, v6 row_newbcast:0 row_mask:0xf bank_mask:0xf
    v_and_b32_dpp v27, v50, v7 row_newbcast:0 row_mask:0xf bank_mask:0xf
    s_waitcnt vmcnt(5)
    s_nop 0
    v_mfma_f32_16x16x32_bf16 v[32:35], v[156:159], v[24:27], v[32:35]
    buffer_load_dwordx4 v[180:183], v1, s[24:27], s83 offen offset:2048 nt
    v_and_b32_dpp v28, v50, v4 row_newbcast:8 row_mask:0xf bank_mask:0xf
    v_and_b32_dpp v29, v50, v5 row_newbcast:8 row_mask:0xf bank_mask:0xf
    v_and_b32_dpp v30, v50, v6 row_newbcast:8 row_mask:0xf bank_mask:0xf
    v_and_b32_dpp v31, v50, v7 row_newbcast:8 row_mask:0xf bank_mask:0xf
    s_waitcnt vmcnt(5)
    s_nop 0
    v_mfma_f32_16x16x32_bf16 v[32:35], v[160:163], v[28:31], v[32:35]
    buffer_load_dwordx4 v[184:187], v1, s[24:27], s83 offen offset:3072 nt
    v_and_b32_dpp v24, v50, v4 row_newbcast:4 row_mask:0xf bank_mask:0xf
    v_and_b32_dpp v25, v50, v5 row_newbcast:4 row_mask:0xf bank_mask:0xf
    v_and_b32_dpp v26, v50, v6 row_newbcast:4 row_mask:0xf bank_mask:0xf
    v_and_b32_dpp v27, v50, v7 row_newbcast:4 row_mask:0xf bank_mask:0xf
    s_waitcnt vmcnt(5)
    s_nop 0
    v_mfma_f32_16x16x32_bf16 v[32:35], v[164:167], v[24:27], v[32:35]
    v_and_b32_dpp v28, v50, v4 row_newbcast:12 row_mask:0xf bank_mask:0xf
    v_and_b32_dpp v29, v50, v5 row_newbcast:12 row_mask:0xf bank_mask:0xf
    v_and_b32_dpp v30, v50, v6 row_newbcast:12 row_mask:0xf bank_mask:0xf
    v_and_b32_dpp v31, v50, v7 row_newbcast:12 row_mask:0xf bank_mask:0xf
    s_waitcnt vmcnt(4)
    s_nop 0
    v_mfma_f32_16x16x32_bf16 v[32:35], v[168:171], v[28:31], v[32:35]
    v_and_b32_dpp v24, v51, v4 row_newbcast:0 row_mask:0xf bank_mask:0xf
    v_and_b32_dpp v25, v51, v5 row_newbcast:0 row_mask:0xf bank_mask:0xf
    v_and_b32_dpp v26, v51, v6 row_newbcast:0 row_mask:0xf bank_mask:0xf
    v_and_b32_dpp v27, v51, v7 row_newbcast:0 row_mask:0xf bank_mask:0xf
    s_waitcnt vmcnt(3)
    s_nop 0
    v_mfma_f32_16x16x32_bf16 v[32:35], v[172:175], v[24:27], v[32:35]
    v_and_b32_dpp v28, v51, v4 row_newbcast:8 row_mask:0xf bank_mask:0xf
    v_and_b32_dpp v29, v51, v5 row_newbcast:8 row_mask:0xf bank_mask:0xf
    v_and_b32_dpp v30, v51, v6 row_newbcast:8 row_mask:0xf bank_mask:0xf
    v_and_b32_dpp v31, v51, v7 row_newbcast:8 row_mask:0xf bank_mask:0xf
    s_waitcnt vmcnt(2)
    s_nop 0
    v_mfma_f32_16x16x32_bf16 v[32:35], v[176:179], v[28:31], v[32:35]
    v_and_b32_dpp v24, v51, v4 row_newbcast:4 row_mask:0xf bank_mask:0xf
    v_and_b32_dpp v25, v51, v5 row_newbcast:4 row_mask:0xf bank_mask:0xf
    v_and_b32_dpp v26, v51, v6 row_newbcast:4 row_mask:0xf bank_mask:0xf
    v_and_b32_dpp v27, v51, v7 row_newbcast:4 row_mask:0xf bank_mask:0xf
    s_waitcnt vmcnt(1)
    s_nop 0
    v_mfma_f32_16x16x32_bf16 v[32:35], v[180:183], v[24:27], v[32:35]
    v_and_b32_dpp v28, v51, v4 row_newbcast:12 row_mask:0xf bank_mask:0xf
    v_and_b32_dpp v29, v51, v5 row_newbcast:12 row_mask:0xf bank_mask:0xf
    v_and_b32_dpp v30, v51, v6 row_newbcast:12 row_mask:0xf bank_mask:0xf
    v_and_b32_dpp v31, v51, v7 row_newbcast:12 row_mask:0xf bank_mask:0xf
    s_waitcnt vmcnt(0)
    s_nop 0
    v_mfma_f32_16x16x32_bf16 v[32:35], v[184:187], v[28:31], v[32:35]
    s_lshl_b32 s54, s48, 9
    v_add_u32 v22, s54, v73
    s_mov_b32 exec_lo, 0x00ff00ff
    s_mov_b32 exec_hi, 0x00ff00ff
    s_nop 3
    ds_write_b128 v22, v[32:35] offset:4096
    s_mov_b64 exec, -1
    v_mov_b32 v19, 0
    s_mul_i32 s54, s48, 2560
    v_add_u32 v22, s54, v73
    s_waitcnt lgkmcnt(0)
    s_barrier
    ds_read_b32 v36, v74 offset:4096
    ds_read_b32 v37, v74 offset:4608
    ds_read_b32 v38, v74 offset:5120
    ds_read_b32 v39, v74 offset:5632
    ds_read_b32 v40, v74 offset:6144
    ds_read_b32 v41, v74 offset:6656
    ds_read_b32 v42, v74 offset:7168
    ds_read_b32 v43, v74 offset:7680
    s_waitcnt lgkmcnt(0)
    v_add_f32 v36, v36, v37
    v_add_f32 v38, v38, v39
    v_add_f32 v40, v40, v41
    v_add_f32 v42, v42, v43
    v_add_f32 v36, v36, v38
    v_add_f32 v40, v40, v42
    v_add_f32 v36, v36, v40
    v_cvt_pk_bf16_f32 v36, v36, v36
    s_nop 1
    v_and_b32_dpp v24, v36, v4 row_newbcast:0 row_mask:0xf bank_mask:0xf
    v_and_b32_dpp v25, v36, v5 row_newbcast:0 row_mask:0xf bank_mask:0xf
    v_and_b32_dpp v26, v36, v6 row_newbcast:0 row_mask:0xf bank_mask:0xf
    v_and_b32_dpp v27, v36, v7 row_newbcast:0 row_mask:0xf bank_mask:0xf
    s_nop 1
    v_mfma_f32_16x16x32_bf16 v[52:55], v[76:79], v[24:27], 0
    v_and_b32_dpp v28, v36, v4 row_newbcast:1 row_mask:0xf bank_mask:0xf
    v_and_b32_dpp v29, v36, v5 row_newbcast:1 row_mask:0xf bank_mask:0xf
    v_and_b32_dpp v30, v36, v6 row_newbcast:1 row_mask:0xf bank_mask:0xf
    v_and_b32_dpp v31, v36, v7 row_newbcast:1 row_mask:0xf bank_mask:0xf
    v_mfma_f32_16x16x32_bf16 v[56:59], v[80:83], v[24:27], 0
    v_mfma_f32_16x16x32_bf16 v[60:63], v[84:87], v[24:27], 0
    v_mfma_f32_16x16x32_bf16 v[64:67], v[88:91], v[24:27], 0
    v_mfma_f32_16x16x32_bf16 v[68:71], v[92:95], v[24:27], 0
    v_mfma_f32_16x16x32_bf16 v[52:55], v[96:99], v[28:31], v[52:55]
    v_and_b32_dpp v24, v36, v4 row_newbcast:2 row_mask:0xf bank_mask:0xf
    v_and_b32_dpp v25, v36, v5 row_newbcast:2 row_mask:0xf bank_mask:0xf
    v_and_b32_dpp v26, v36, v6 row_newbcast:2 row_mask:0xf bank_mask:0xf
    v_and_b32_dpp v27, v36, v7 row_newbcast:2 row_mask:0xf bank_mask:0xf
    v_mfma_f32_16x16x32_bf16 v[56:59], v[100:103], v[28:31], v[56:59]
    v_mfma_f32_16x16x32_bf16 v[60:63], v[104:107], v[28:31], v[60:63]
    v_mfma_f32_16x16x32_bf16 v[64:67], v[108:111], v[28:31], v[64:67]
    v_mfma_f32_16x16x32_bf16 v[68:71], v[112:115], v[28:31], v[68:71]
    v_mfma_f32_16x16x32_bf16 v[52:55], v[116:119], v[24:27], v[52:55]
    v_and_b32_dpp v28, v36, v4 row_newbcast:3 row_mask:0xf bank_mask:0xf
    v_and_b32_dpp v29, v36, v5 row_newbcast:3 row_mask:0xf bank_mask:0xf
    v_and_b32_dpp v30, v36, v6 row_newbcast:3 row_mask:0xf bank_mask:0xf
    v_and_b32_dpp v31, v36, v7 row_newbcast:3 row_mask:0xf bank_mask:0xf
    v_mfma_f32_16x16x32_bf16 v[56:59], v[120:123], v[24:27], v[56:59]
    v_mfma_f32_16x16x32_bf16 v[60:63], v[124:127], v[24:27], v[60:63]
    v_mfma_f32_16x16x32_bf16 v[64:67], v[128:131], v[24:27], v[64:67]
    v_mfma_f32_16x16x32_bf16 v[68:71], v[132:135], v[24:27], v[68:71]
    v_mfma_f32_16x16x32_bf16 v[52:55], v[136:139], v[28:31], v[52:55]
    v_mfma_f32_16x16x32_bf16 v[56:59], v[140:143], v[28:31], v[56:59]
    v_mfma_f32_16x16x32_bf16 v[60:63], v[144:147], v[28:31], v[60:63]
    v_mfma_f32_16x16x32_bf16 v[64:67], v[148:151], v[28:31], v[64:67]
    v_mfma_f32_16x16x32_bf16 v[68:71], v[152:155], v[28:31], v[68:71]
    s_mov_b32 exec_lo, 0x00ff00ff
    s_mov_b32 exec_hi, 0x00ff00ff
    s_nop 1
    ds_write_b128 v22, v[52:55] offset:8448
    ds_write_b128 v22, v[56:59] offset:8960
    ds_write_b128 v22, v[60:63] offset:9472
    ds_write_b128 v22, v[64:67] offset:9984
    ds_write_b128 v22, v[68:71] offset:10496
    s_mov_b64 exec, -1
    v_lshlrev_b32 v22, 4, v0
    s_waitcnt lgkmcnt(0)
    s_barrier
    s_cmp_ge_u32 s48, 3
    s_cbranch_scc1 L_finB
    v_cmp_gt_u32 vcc, 160, v0
    s_nop 2
    s_and_saveexec_b64 s[66:67], vcc
    ds_read_b128 v[76:79], v22 offset:8448
    ds_read_b128 v[80:83], v22 offset:11008
    ds_read_b128 v[84:87], v22 offset:13568
    ds_read_b128 v[88:91], v22 offset:16128
    ds_read_b128 v[92:95], v22 offset:18688
    ds_read_b128 v[96:99], v22 offset:21248
    ds_read_b128 v[100:103], v22 offset:23808
    ds_read_b128 v[104:107], v22 offset:26368
    s_waitcnt lgkmcnt(0)
    v_add_f32 v76, v76, v80
    v_add_f32 v77, v77, v81
    v_add_f32 v78, v78, v82
    v_add_f32 v79, v79, v83
    v_add_f32 v84, v84, v88
    v_add_f32 v85, v85, v89
    v_add_f32 v86, v86, v90
    v_add_f32 v87, v87, v91
    v_add_f32 v92, v92, v96
    v_add_f32 v93, v93, v97
    v_add_f32 v94, v94, v98
    v_add_f32 v95, v95, v99
    v_add_f32 v100, v100, v104
    v_add_f32 v101, v101, v105
    v_add_f32 v102, v102, v106
    v_add_f32 v103, v103, v107
    v_add_f32 v76, v76, v84
    v_add_f32 v77, v77, v85
    v_add_f32 v78, v78, v86
    v_add_f32 v79, v79, v87
    v_add_f32 v92, v92, v100
    v_add_f32 v93, v93, v101
    v_add_f32 v94, v94, v102
    v_add_f32 v95, v95, v103
    v_add_f32 v76, v76, v92
    v_add_f32 v77, v77, v93
    v_add_f32 v78, v78, v94
    v_add_f32 v79, v79, v95
    v_mov_b32 v84, v76
    v_mov_b32 v85, v77
    v_mov_b32 v86, s14
    v_mov_b32 v87, s15
    v_mov_b32 v88, v78
    v_mov_b32 v89, v79
    v_mov_b32 v90, s14
    v_mov_b32 v91, s15
    buffer_store_dwordx4 v[84:87], v72, s[40:43], 0 offen sc1
    buffer_store_dwordx4 v[88:91], v72, s[40:43], 0 offen offset:128 sc1
    s_mov_b64 exec, -1
    s_cmp_lg_u32 s48, 0
    s_cbranch_scc1 L_finB
    s_cmp_ge_u32 s52, 20
    s_cbranch_scc1 L_finB
    v_lshlrev_b32 v73, 4, v0
    s_lshl_b32 s55, s52, 13
    v_add_u32 v73, s55, v73
    v_add_u32 v74, 4096, v73
    s_mov_b32 s53, 0
L_pollB:
    s_add_u32 s53, s53, 1
    s_cmp_gt_u32 s53, 200000
    s_cbranch_scc1 L_finB
    buffer_load_dwordx4 v[92:95], v73, s[40:43], 0 offen offset:0 sc1
    buffer_load_dwordx4 v[96:99], v73, s[40:43], 0 offen offset:1024 sc1
    buffer_load_dwordx4 v[100:103], v73, s[40:43], 0 offen offset:2048 sc1
    buffer_load_dwordx4 v[104:107], v73, s[40:43], 0 offen offset:3072 sc1
    buffer_load_dwordx4 v[108:111], v74, s[40:43], 0 offen offset:0 sc1
    buffer_load_dwordx4 v[112:115], v74, s[40:43], 0 offen offset:1024 sc1
    buffer_load_dwordx4 v[116:119], v74, s[40:43], 0 offen offset:2048 sc1
    buffer_load_dwordx4 v[120:123], v74, s[40:43], 0 offen offset:3072 sc1
    v_mov_b32 v16, 0
    s_waitcnt vmcnt(7)
    v_xor_b32 v17, s14, v94
    v_xor_b32 v18, s15, v95
    v_or3_b32 v16, v16, v17, v18
    s_waitcnt vmcnt(6)
    v_xor_b32 v17, s14, v98
    v_xor_b32 v18, s15, v99
    v_or3_b32 v16, v16, v17, v18
    s_waitcnt vmcnt(5)
    v_xor_b32 v17, s14, v102
    v_xor_b32 v18, s15, v103
    v_or3_b32 v16, v16, v17, v18
    s_waitcnt vmcnt(4)
    v_xor_b32 v17, s14, v106
    v_xor_b32 v18, s15, v107
    v_or3_b32 v16, v16, v17, v18
    s_waitcnt vmcnt(3)
    v_xor_b32 v17, s14, v110
    v_xor_b32 v18, s15, v111
    v_or3_b32 v16, v16, v17, v18
    s_waitcnt vmcnt(2)
    v_xor_b32 v17, s14, v114
    v_xor_b32 v18, s15, v115
    v_or3_b32 v16, v16, v17, v18
    s_waitcnt vmcnt(1)
    v_xor_b32 v17, s14, v118
    v_xor_b32 v18, s15, v119
    v_or3_b32 v16, v16, v17, v18
    s_waitcnt vmcnt(0)
    v_xor_b32 v17, s14, v122
    v_xor_b32 v18, s15, v123
    v_or3_b32 v16, v16, v17, v18
    v_cmp_ne_u32 vcc, 0, v16
    s_cbranch_vccnz L_pollB
    v_add_f32 v92, v92, v96
    v_add_f32 v93, v93, v97
    v_add_f32 v100, v100, v104
    v_add_f32 v101, v101, v105
    v_add_f32 v108, v108, v112
    v_add_f32 v109, v109, v113
    v_add_f32 v116, v116, v120
    v_add_f32 v117, v117, v121
    v_add_f32 v92, v92, v100
    v_add_f32 v93, v93, v101
    v_add_f32 v108, v108, v116
    v_add_f32 v109, v109, v117
    v_add_f32 v92, v92, v108
    v_add_f32 v93, v93, v109
    v_mov_b32 v96, v92
    v_mov_b32 v97, v93
    s_nop 0
    v_permlane16_swap_b32 v92, v96
    v_permlane16_swap_b32 v93, v97
    v_add_f32 v92, v92, v96
    v_add_f32 v93, v93, v97
    v_mov_b32 v96, v92
    v_mov_b32 v97, v93
    s_nop 0
    v_permlane32_swap_b32 v92, v96
    v_permlane32_swap_b32 v93, v97
    v_add_f32 v92, v92, v96
    v_add_f32 v93, v93, v97
    v_cvt_pk_bf16_f32 v92, v92, v92
    v_cvt_pk_bf16_f32 v93, v93, v93
    v_and_b32 v22, 7, v0
    v_lshlrev_b32 v22, 1, v22
    v_bfe_u32 v23, v0, 3, 1
    v_lshl_add_u32 v22, v23, 5, v22
    s_lshl_b32 s55, s52, 6
    s_mov_b64 exec, 0xffff
    buffer_store_short v92, v22, s[44:47], s55 offen offset:0
    buffer_store_short v93, v22, s[44:47], s55 offen offset:16
    s_cmp_lg_u32 s52, 0
    s_cbranch_scc1 L_finB
    s_mov_b64 exec, 1
    s_lshl_b32 s54, s60, 7
    s_add_u32 s54, s54, 1310720
    v_mov_b32 v22, s54
    v_mov_b32 v96, s14
    v_mov_b32 v97, s15
    global_store_dwordx2 v22, v[96:97], s[18:19]
L_finB:
    s_endpgm
L_end:
    s_endpgm
.section .rodata,"a"
.p2align 6
.amdhsa_kernel concat_heads__sliding_block_cached__sliding_block_cached__decode_kernel
  .amdhsa_next_free_vgpr 204
  .amdhsa_next_free_sgpr 102
  .amdhsa_accum_offset 204
  .amdhsa_group_segment_fixed_size 0
  .amdhsa_kernarg_size 104
  .amdhsa_user_sgpr_count 2
  .amdhsa_user_sgpr_kernarg_segment_ptr 1
  .amdhsa_system_sgpr_workgroup_id_x 1
.end_amdhsa_kernel
```
